```python
import torch

def _softmax(x, axis=-1):
    return torch.softmax(x, dim=axis)
def _gelu(x):
    return torch.nn.functional.gelu(x, approximate="tanh")
def _silu(x):
    return torch.nn.functional.silu(x)
def _sigmoid(x):
    return torch.sigmoid(x)
def _layernorm(x, axis=-1, eps=1e-5):
    m = x.mean(dim=axis, keepdim=True)
    v = x.var(dim=axis, keepdim=True, unbiased=False)
    return (x - m) / torch.sqrt(v + eps)
def _scatter_add(tgt, idx, src, axis=0):
    return tgt.clone().index_add_(axis, idx, src)
def _segment_sum(src, seg, n):
    out = torch.zeros((n,) + src.shape[1:], dtype=src.dtype)
    return out.index_add_(0, seg, src)
def _pad(x, pw):
    flat = tuple(v for pair in reversed(pw) for v in pair)
    return torch.nn.functional.pad(x, flat)

kernel_name = 'standalone__kv_cache_quant_int4_int2_kv_with_per_channel_or_per_token_scales__decode'

def setup_inputs():

    _w = (lambda a: (lambda t: t.to(torch.bfloat16) if t.is_floating_point() else t)(torch.as_tensor(a)))
    B = 1
    Sq = 1
    Skv = 65536
    Hq = 32
    Hkv = 16
    Dh = 128
    bits = 4
    G = -1
    if G <= 0 or G >= Skv:
        G = max(1, Skv // 2)
    Skv = (Skv // G) * G
    ngk = Skv // G
    qmax = (1 << bits) - 1
    return {
        "q": _w((lambda *s: torch.randn(*s, dtype=torch.bfloat16) * 1.6)(B, Hq, Sq, Dh)),
        "qk": _w(torch.randint(0, qmax + 1, (B, Hkv, Skv, Dh)).to(torch.int32)),
        "qv": _w(torch.randint(0, qmax + 1, (B, Hkv, Skv, Dh)).to(torch.int32)),
        "k_scales": _w(torch.abs((lambda *s: torch.randn(*s, dtype=torch.bfloat16) * 1.6)(B, Hkv, ngk, Dh)) * 0.05 + 0.02),
        "k_zeros": _w((lambda *s: torch.randn(*s, dtype=torch.bfloat16) * 1.6)(B, Hkv, ngk, Dh) + float(qmax) / 2.0),
        "v_scales": _w(torch.abs((lambda *s: torch.randn(*s, dtype=torch.bfloat16) * 0.05)(B, Hkv, Skv, 1)) * 0.05 + 0.02),
        "v_zeros": _w((lambda *s: torch.randn(*s, dtype=torch.bfloat16) * 0.05)(B, Hkv, Skv, 1) + float(qmax) / 2.0),
    }

def reference(q, qk, qv, k_scales, k_zeros, v_scales, v_zeros):
    B, Hq, Sq, Dh = q.shape
    Hkv, Skv = qk.shape[1], qk.shape[2]
    ngk = k_scales.shape[2]
    G = Skv // ngk
    ks = (lambda x, n, axis: torch.repeat_interleave(x, n, dim=axis))(k_scales, G, axis=2)
    kz = (lambda x, n, axis: torch.repeat_interleave(x, n, dim=axis))(k_zeros, G, axis=2)
    k = ((lambda x, dt: x.to(dt))(qk, q.dtype) - kz) * ks
    v = ((lambda x, dt: x.to(dt))(qv, q.dtype) - v_zeros) * v_scales
    rep = Hq // Hkv
    if rep > 1:
        k = (lambda x, n, axis: torch.repeat_interleave(x, n, dim=axis))(k, rep, axis=1)
        v = (lambda x, n, axis: torch.repeat_interleave(x, n, dim=axis))(v, rep, axis=1)
    scale = float(Dh) ** -0.5
    logits = torch.einsum("bhqd,bhkd->bhqk", q, k) * scale
    p = _softmax(logits, axis=-1)
    o = torch.einsum("bhqk,bhkd->bhqd", p, v)
    return o
```

```asm
; @launch kernel=standalone__kv_cache_quant_int4_int2_kv_with_per_channel_or_per_token_scales__decode_kernel grid=(257,1,1) block=(256,1,1) lds=6240
.amdgcn_target "amdgcn-amd-amdhsa--gfx950"
.text
.globl standalone__kv_cache_quant_int4_int2_kv_with_per_channel_or_per_token_scales__decode_kernel
.p2align 8
.type standalone__kv_cache_quant_int4_int2_kv_with_per_channel_or_per_token_scales__decode_kernel,@function
standalone__kv_cache_quant_int4_int2_kv_with_per_channel_or_per_token_scales__decode_kernel:
    s_cmp_ge_u32 s2, 256
    s_cbranch_scc1 L_init
    s_load_dwordx16 s[60:75], s[0:1], 0
    s_load_dwordx4 s[76:79], s[0:1], 64
    v_lshrrev_b32 v6, 6, v0
    v_and_b32 v18, 63, v0
    v_readfirstlane_b32 s54, v6
    v_lshrrev_b32 v6, 3, v18
    v_and_b32 v7, 7, v18
    v_lshlrev_b32 v0, 9, v6
    v_lshl_add_u32 v0, v7, 4, v0
    s_lshr_b32 s94, s2, 3
    s_lshl_b32 s57, s94, 24
    s_and_b32 s3, s2, 7
    s_lshr_b32 s59, s2, 7
    s_lshl_b32 s85, s54, 3
    s_lshl_b32 s95, s3, 12
    s_lshr_b32 s58, s54, 1
    s_lshl_b32 s58, s58, 5
    s_and_b32 s92, s54, 1
    s_lshl_b32 s92, s92, 3
    s_add_u32 s92, s92, s58
    s_mov_b32 s91, s59
    s_add_u32 s95, s95, s85
    s_lshl_b32 s40, s95, 9
    s_lshl_b32 s41, s95, 9
    s_mov_b32 s10, 16777216
    s_mov_b32 s11, 0x00020000
    s_mov_b32 s14, 16777216
    s_mov_b32 s15, 0x00020000
    v_lshrrev_b32 v5, 2, v7
    v_and_b32 v19, 2, v7
    v_add_u32 v5, v5, v19
    v_and_b32 v19, 1, v7
    v_lshl_add_u32 v5, v19, 2, v5
    v_mov_b32 v1, v5
    v_lshlrev_b32 v165, 1, v6
    v_lshl_add_u32 v167, v5, 6, v165
    s_lshl_b32 s58, s54, 9
    v_lshlrev_b32 v3, 6, v6
    v_add_u32 v3, s58, v3
    v_lshl_add_u32 v2, v5, 3, v3
    s_mov_b32 s44, 0xcccccccc
    s_mov_b32 s45, 0xcccccccc
    s_mov_b32 s46, 0xaaaaaaaa
    s_mov_b32 s47, 0xaaaaaaaa
    s_lshl_b32 s55, s2, 2
    s_add_u32 s55, s55, s54
    s_lshr_b32 s56, s2, 4
    s_and_b32 s84, s2, 15
    s_cmp_eq_u32 s54, 0
    s_cselect_b32 s85, 3, 1000
    v_lshlrev_b32 v19, 3, v7
    v_lshlrev_b32 v6, 4, v18
    s_mov_b32 s18, 65536
    s_mov_b32 s19, 0x00020000
    s_mov_b32 s22, 65536
    s_mov_b32 s23, 0x00020000
    s_mov_b32 s26, 8192
    s_mov_b32 s27, 0x00020000
    s_mov_b32 s30, 8192
    s_mov_b32 s31, 0x00020000
    s_mov_b32 s34, 8192
    s_mov_b32 s35, 0x00020000
    s_mov_b32 s38, 16777216
    s_mov_b32 s39, 0x00020000
    s_mov_b32 s6, 256
    s_mov_b32 s7, 0x00020000
    s_waitcnt lgkmcnt(0)
    s_add_u32 s8, s62, s57
    s_addc_u32 s9, s63, 0
    s_add_u32 s12, s64, s57
    s_addc_u32 s13, s65, 0
    s_lshl_b32 s58, s94, 16
    s_add_u32 s16, s70, s58
    s_addc_u32 s17, s71, 0
    s_add_u32 s20, s72, s58
    s_addc_u32 s21, s73, 0
    s_mov_b32 s24, s60
    s_mov_b32 s25, s61
    s_mov_b32 s28, s66
    s_mov_b32 s29, s67
    s_mov_b32 s32, s68
    s_mov_b32 s33, s69
    s_mov_b32 s36, s78
    s_mov_b32 s37, s79
    s_mov_b32 s4, s76
    s_mov_b32 s5, s77
    s_lshl_b32 s58, s56, 9
    s_lshl_b32 s59, s94, 8
    buffer_load_dwordx2 v[52:53], v19, s[24:27], s58 offen offset:0
    buffer_load_dwordx2 v[68:69], v19, s[28:31], s59 offen offset:0
    buffer_load_dwordx2 v[76:77], v19, s[32:35], s59 offen offset:0
    buffer_load_dwordx2 v[54:55], v19, s[24:27], s58 offen offset:64
    buffer_load_dwordx2 v[56:57], v19, s[24:27], s58 offen offset:128
    buffer_load_dwordx2 v[58:59], v19, s[24:27], s58 offen offset:192
    buffer_load_dwordx2 v[60:61], v19, s[24:27], s58 offen offset:256
    buffer_load_dwordx2 v[62:63], v19, s[24:27], s58 offen offset:320
    buffer_load_dwordx2 v[64:65], v19, s[24:27], s58 offen offset:384
    buffer_load_dwordx2 v[66:67], v19, s[24:27], s58 offen offset:448
    buffer_load_dwordx2 v[70:71], v19, s[28:31], s59 offen offset:64
    buffer_load_dwordx2 v[72:73], v19, s[28:31], s59 offen offset:128
    buffer_load_dwordx2 v[74:75], v19, s[28:31], s59 offen offset:192
    buffer_load_dwordx2 v[78:79], v19, s[32:35], s59 offen offset:64
    buffer_load_dwordx2 v[80:81], v19, s[32:35], s59 offen offset:128
    buffer_load_dwordx2 v[82:83], v19, s[32:35], s59 offen offset:192
    s_and_b32 s58, s2, 7
    s_lshl_b32 s58, s58, 13
    s_mul_i32 s59, s54, 2048
    s_add_u32 s58, s58, s59
    buffer_load_dwordx4 v[20:23], v6, s[16:19], s58 offen offset:0
    buffer_load_dwordx4 v[24:27], v6, s[20:23], s58 offen offset:0
    buffer_load_dwordx4 v[28:31], v6, s[16:19], s58 offen offset:1024
    buffer_load_dwordx4 v[32:35], v6, s[20:23], s58 offen offset:1024
    s_lshl_b32 s42, s95, 1
    buffer_load_ushort v168, v167, s[16:19], s42 offen
    buffer_load_ushort v169, v167, s[20:23], s42 offen
    s_mov_b32 s69, 16384
    buffer_load_dwordx4 v[100:103], v0, s[8:11], s40 offen offset:0 nt
    buffer_load_dwordx4 v[104:107], v0, s[8:11], s40 offen offset:128 nt
    buffer_load_dwordx4 v[108:111], v0, s[8:11], s40 offen offset:256 nt
    buffer_load_dwordx4 v[112:115], v0, s[8:11], s40 offen offset:384 nt
    s_add_u32 s40, s40, s69
    buffer_load_dwordx4 v[116:119], v0, s[8:11], s40 offen offset:0 nt
    buffer_load_dwordx4 v[120:123], v0, s[8:11], s40 offen offset:128 nt
    buffer_load_dwordx4 v[124:127], v0, s[8:11], s40 offen offset:256 nt
    buffer_load_dwordx4 v[128:131], v0, s[8:11], s40 offen offset:384 nt
    s_add_u32 s40, s40, s69
    buffer_load_dwordx4 v[132:135], v0, s[8:11], s40 offen offset:0 nt
    buffer_load_dwordx4 v[136:139], v0, s[8:11], s40 offen offset:128 nt
    buffer_load_dwordx4 v[140:143], v0, s[8:11], s40 offen offset:256 nt
    buffer_load_dwordx4 v[144:147], v0, s[8:11], s40 offen offset:384 nt
    s_add_u32 s40, s40, s69
    buffer_load_dwordx4 v[148:151], v0, s[8:11], s40 offen offset:0 nt
    buffer_load_dwordx4 v[152:155], v0, s[8:11], s40 offen offset:128 nt
    buffer_load_dwordx4 v[156:159], v0, s[8:11], s40 offen offset:256 nt
    buffer_load_dwordx4 v[160:163], v0, s[8:11], s40 offen offset:384 nt
    s_add_u32 s40, s40, s69
    s_mul_i32 s94, s94, 8192
    s_add_u32 s94, s94, 12582912
    v_mov_b32 v166, 256
    s_mov_b32 s58, 224
    v_writelane_b32 v166, s58, 0
    s_mov_b32 s58, 226
    v_writelane_b32 v166, s58, 1
    s_mov_b32 s58, 228
    v_writelane_b32 v166, s58, 2
    s_mov_b32 s58, 230
    v_writelane_b32 v166, s58, 3
    s_mov_b32 s58, 232
    v_writelane_b32 v166, s58, 4
    s_mov_b32 s58, 234
    v_writelane_b32 v166, s58, 5
    s_mov_b32 s58, 236
    v_writelane_b32 v166, s58, 6
    s_mov_b32 s58, 238
    v_writelane_b32 v166, s58, 7
    s_mov_b32 s58, 240
    v_writelane_b32 v166, s58, 8
    s_mov_b32 s58, 241
    v_writelane_b32 v166, s58, 9
    s_mov_b32 s58, 242
    v_writelane_b32 v166, s58, 10
    s_mov_b32 s58, 243
    v_writelane_b32 v166, s58, 11
    s_mov_b32 s58, 244
    v_writelane_b32 v166, s58, 12
    s_mov_b32 s58, 245
    v_writelane_b32 v166, s58, 13
    s_mov_b32 s58, 246
    v_writelane_b32 v166, s58, 14
    s_mov_b32 s58, 247
    v_writelane_b32 v166, s58, 15
    s_mov_b32 s58, 248
    v_writelane_b32 v166, s58, 16
    s_mov_b32 s58, 249
    v_writelane_b32 v166, s58, 17
    s_mov_b32 s58, 250
    v_writelane_b32 v166, s58, 18
    s_mov_b32 s58, 251
    v_writelane_b32 v166, s58, 19
    s_mov_b32 s58, 252
    v_writelane_b32 v166, s58, 20
    s_mov_b32 s58, 253
    v_writelane_b32 v166, s58, 21
    s_mov_b32 s58, 254
    v_writelane_b32 v166, s58, 22
    s_mov_b32 s58, 255
    v_writelane_b32 v166, s58, 23
    v_mov_b32 v5, 0
    ds_write_b32 v5, v5 offset:6212
    v_mov_b32 v8, 0
    v_mov_b32 v9, 0
    v_mov_b32 v10, 0
    v_mov_b32 v11, 0
    v_mov_b32 v4, 0xff61b1e6
    s_mov_b32 s43, 0
    s_mov_b32 s58, 0x3e0293ee
    s_waitcnt vmcnt(16)
    s_mov_b32 s24, s8
    s_mov_b32 s25, s9
    s_mov_b32 s26, 16777216
    s_mov_b32 s27, 0x00020000
    s_mov_b32 s29, 4
    s_mov_b32 s30, 32768
    s_mov_b32 s32, 0xeeeeeeee
    s_mov_b32 s33, 0xeeeeeeee
    s_sub_u32 s35, s85, 0
    s_mov_b32 s34, s92
    s_mov_b32 s31, s91
    s_mov_b32 s62, 0
    s_mov_b32 s73, 2
    s_lshl_b32 s72, s54, 3
    s_mov_b32 s63, 0
    s_mov_b32 s64, 0
    s_mov_b32 s70, 0
    s_mov_b32 s65, 0
    s_mov_b32 s67, 0
    v_lshlrev_b32 v84, 16, v68
    v_and_b32 v85, 0xffff0000, v68
    v_lshlrev_b32 v86, 16, v69
    v_and_b32 v87, 0xffff0000, v69
    v_lshlrev_b32 v88, 16, v70
    v_and_b32 v89, 0xffff0000, v70
    v_lshlrev_b32 v90, 16, v71
    v_and_b32 v91, 0xffff0000, v71
    v_lshlrev_b32 v92, 16, v72
    v_and_b32 v93, 0xffff0000, v72
    v_lshlrev_b32 v94, 16, v73
    v_and_b32 v95, 0xffff0000, v73
    v_lshlrev_b32 v96, 16, v74
    v_and_b32 v97, 0xffff0000, v74
    v_lshlrev_b32 v98, 16, v75
    v_and_b32 v99, 0xffff0000, v75
    v_mul_f32 v84, s58, v84
    v_mul_f32 v85, s58, v85
    v_mul_f32 v86, s58, v86
    v_mul_f32 v87, s58, v87
    v_mul_f32 v88, s58, v88
    v_mul_f32 v89, s58, v89
    v_mul_f32 v90, s58, v90
    v_mul_f32 v91, s58, v91
    v_mul_f32 v92, s58, v92
    v_mul_f32 v93, s58, v93
    v_mul_f32 v94, s58, v94
    v_mul_f32 v95, s58, v95
    v_mul_f32 v96, s58, v96
    v_mul_f32 v97, s58, v97
    v_mul_f32 v98, s58, v98
    v_mul_f32 v99, s58, v99
    s_waitcnt lgkmcnt(0)
    v_lshlrev_b32 v20, 16, v52
    v_and_b32 v22, 0xffff0000, v52
    v_lshlrev_b32 v24, 16, v53
    v_and_b32 v26, 0xffff0000, v53
    v_lshlrev_b32 v28, 16, v54
    v_and_b32 v30, 0xffff0000, v54
    v_lshlrev_b32 v32, 16, v55
    v_and_b32 v34, 0xffff0000, v55
    v_lshlrev_b32 v36, 16, v56
    v_and_b32 v38, 0xffff0000, v56
    v_lshlrev_b32 v40, 16, v57
    v_and_b32 v42, 0xffff0000, v57
    v_lshlrev_b32 v44, 16, v58
    v_and_b32 v46, 0xffff0000, v58
    v_lshlrev_b32 v48, 16, v59
    v_and_b32 v50, 0xffff0000, v59
    v_lshlrev_b32 v21, 16, v60
    v_and_b32 v23, 0xffff0000, v60
    v_lshlrev_b32 v25, 16, v61
    v_and_b32 v27, 0xffff0000, v61
    v_lshlrev_b32 v29, 16, v62
    v_and_b32 v31, 0xffff0000, v62
    v_lshlrev_b32 v33, 16, v63
    v_and_b32 v35, 0xffff0000, v63
    v_lshlrev_b32 v37, 16, v64
    v_and_b32 v39, 0xffff0000, v64
    v_lshlrev_b32 v41, 16, v65
    v_and_b32 v43, 0xffff0000, v65
    v_lshlrev_b32 v45, 16, v66
    v_and_b32 v47, 0xffff0000, v66
    v_lshlrev_b32 v49, 16, v67
    v_and_b32 v51, 0xffff0000, v67
    v_mul_f32 v20, v20, v84
    v_mul_f32 v21, v21, v84
    v_mul_f32 v22, v22, v85
    v_mul_f32 v23, v23, v85
    v_mul_f32 v24, v24, v86
    v_mul_f32 v25, v25, v86
    v_mul_f32 v26, v26, v87
    v_mul_f32 v27, v27, v87
    v_mul_f32 v28, v28, v88
    v_mul_f32 v29, v29, v88
    v_mul_f32 v30, v30, v89
    v_mul_f32 v31, v31, v89
    v_mul_f32 v32, v32, v90
    v_mul_f32 v33, v33, v90
    v_mul_f32 v34, v34, v91
    v_mul_f32 v35, v35, v91
    v_mul_f32 v36, v36, v92
    v_mul_f32 v37, v37, v92
    v_mul_f32 v38, v38, v93
    v_mul_f32 v39, v39, v93
    v_mul_f32 v40, v40, v94
    v_mul_f32 v41, v41, v94
    v_mul_f32 v42, v42, v95
    v_mul_f32 v43, v43, v95
    v_mul_f32 v44, v44, v96
    v_mul_f32 v45, v45, v96
    v_mul_f32 v46, v46, v97
    v_mul_f32 v47, v47, v97
    v_mul_f32 v48, v48, v98
    v_mul_f32 v49, v49, v98
    v_mul_f32 v50, v50, v99
    v_mul_f32 v51, v51, v99
    v_lshlrev_b32 v84, 16, v76
    v_and_b32 v85, 0xffff0000, v76
    v_lshlrev_b32 v86, 16, v77
    v_and_b32 v87, 0xffff0000, v77
    v_lshlrev_b32 v88, 16, v78
    v_and_b32 v89, 0xffff0000, v78
    v_lshlrev_b32 v90, 16, v79
    v_and_b32 v91, 0xffff0000, v79
    v_lshlrev_b32 v92, 16, v80
    v_and_b32 v93, 0xffff0000, v80
    v_lshlrev_b32 v94, 16, v81
    v_and_b32 v95, 0xffff0000, v81
    v_lshlrev_b32 v96, 16, v82
    v_and_b32 v97, 0xffff0000, v82
    v_lshlrev_b32 v98, 16, v83
    v_and_b32 v99, 0xffff0000, v83
    v_mul_f32 v6, v20, v84
    v_fmac_f32 v6, v22, v85
    v_fmac_f32 v6, v24, v86
    v_fmac_f32 v6, v26, v87
    v_fmac_f32 v6, v28, v88
    v_fmac_f32 v6, v30, v89
    v_fmac_f32 v6, v32, v90
    v_fmac_f32 v6, v34, v91
    v_fmac_f32 v6, v36, v92
    v_fmac_f32 v6, v38, v93
    v_fmac_f32 v6, v40, v94
    v_fmac_f32 v6, v42, v95
    v_fmac_f32 v6, v44, v96
    v_fmac_f32 v6, v46, v97
    v_fmac_f32 v6, v48, v98
    v_fmac_f32 v6, v50, v99
    v_mul_f32 v7, v21, v84
    v_fmac_f32 v7, v23, v85
    v_fmac_f32 v7, v25, v86
    v_fmac_f32 v7, v27, v87
    v_fmac_f32 v7, v29, v88
    v_fmac_f32 v7, v31, v89
    v_fmac_f32 v7, v33, v90
    v_fmac_f32 v7, v35, v91
    v_fmac_f32 v7, v37, v92
    v_fmac_f32 v7, v39, v93
    v_fmac_f32 v7, v41, v94
    v_fmac_f32 v7, v43, v95
    v_fmac_f32 v7, v45, v96
    v_fmac_f32 v7, v47, v97
    v_fmac_f32 v7, v49, v98
    v_fmac_f32 v7, v51, v99
    v_add_f32_dpp v6, v6, v6 quad_perm:[1,0,3,2] row_mask:0xf bank_mask:0xf
    s_nop 0
    v_add_f32_dpp v7, v7, v7 quad_perm:[1,0,3,2] row_mask:0xf bank_mask:0xf
    v_add_f32_dpp v6, v6, v6 quad_perm:[2,3,0,1] row_mask:0xf bank_mask:0xf
    s_nop 0
    v_add_f32_dpp v7, v7, v7 quad_perm:[2,3,0,1] row_mask:0xf bank_mask:0xf
    v_add_f32_dpp v6, v6, v6 row_half_mirror row_mask:0xf bank_mask:0xf
    s_nop 0
    v_add_f32_dpp v7, v7, v7 row_half_mirror row_mask:0xf bank_mask:0xf
    v_readfirstlane_b32 s52, v6
    v_readfirstlane_b32 s53, v7
    v_mov_b32 v52, 0
    v_mov_b32 v53, 0
    v_mov_b32 v54, 0
    v_mov_b32 v55, 0
    v_mov_b32 v56, 0
    v_mov_b32 v57, 0
    v_mov_b32 v58, 0
    v_mov_b32 v59, 0
    v_mov_b32 v60, 0
    v_mov_b32 v61, 0
    v_mov_b32 v62, 0
    v_mov_b32 v63, 0
    v_mov_b32 v64, 0
    v_mov_b32 v65, 0
    v_mov_b32 v66, 0
    v_mov_b32 v67, 0
    v_mov_b32 v68, 0
    v_mov_b32 v69, 0
    v_mov_b32 v70, 0
    v_mov_b32 v71, 0
    v_mov_b32 v72, 0
    v_mov_b32 v73, 0
    v_mov_b32 v74, 0
    v_mov_b32 v75, 0
    v_mov_b32 v76, 0
    v_mov_b32 v77, 0
    v_mov_b32 v78, 0
    v_mov_b32 v79, 0
    v_mov_b32 v80, 0
    v_mov_b32 v81, 0
    v_mov_b32 v82, 0
    v_mov_b32 v83, 0
    s_nop 4
L_body8:
    s_barrier
    s_waitcnt vmcnt(15)
    v_mov_b32 v12, v168
    v_mov_b32 v13, v169
    v_cvt_f32_i32 v100, v100
    v_cvt_f32_i32 v101, v101
    v_cvt_f32_i32 v102, v102
    v_cvt_f32_i32 v103, v103
    v_pk_mul_f32 v[84:85], v[100:101], v[20:21] op_sel:[0,0] op_sel_hi:[0,1]
    v_pk_fma_f32 v[84:85], v[100:101], v[22:23], v[84:85] op_sel:[1,0,0] op_sel_hi:[1,1,1]
    v_pk_fma_f32 v[84:85], v[102:103], v[24:25], v[84:85] op_sel:[0,0,0] op_sel_hi:[0,1,1]
    v_pk_fma_f32 v[84:85], v[102:103], v[26:27], v[84:85] op_sel:[1,0,0] op_sel_hi:[1,1,1]
    s_cmp_lg_u32 s43, s35
    s_cbranch_scc1 L_nf8
    s_mov_b64 exec, 1
    buffer_load_dword v170, v5, s[4:7], 0 offen sc1
    s_mov_b64 exec, -1
    s_nop 4
L_nf8:
    buffer_load_dwordx4 v[100:103], v0, s[8:11], s40 offen offset:0 nt
    s_waitcnt vmcnt(15)
    v_cvt_f32_i32 v104, v104
    v_cvt_f32_i32 v105, v105
    v_cvt_f32_i32 v106, v106
    v_cvt_f32_i32 v107, v107
    v_pk_fma_f32 v[84:85], v[104:105], v[28:29], v[84:85] op_sel:[0,0,0] op_sel_hi:[0,1,1]
    v_pk_fma_f32 v[84:85], v[104:105], v[30:31], v[84:85] op_sel:[1,0,0] op_sel_hi:[1,1,1]
    v_pk_fma_f32 v[84:85], v[106:107], v[32:33], v[84:85] op_sel:[0,0,0] op_sel_hi:[0,1,1]
    v_pk_fma_f32 v[84:85], v[106:107], v[34:35], v[84:85] op_sel:[1,0,0] op_sel_hi:[1,1,1]
    buffer_load_dwordx4 v[104:107], v0, s[8:11], s40 offen offset:128 nt
    s_waitcnt vmcnt(15)
    v_cvt_f32_i32 v108, v108
    v_cvt_f32_i32 v109, v109
    v_cvt_f32_i32 v110, v110
    v_cvt_f32_i32 v111, v111
    v_pk_fma_f32 v[84:85], v[108:109], v[36:37], v[84:85] op_sel:[0,0,0] op_sel_hi:[0,1,1]
    v_pk_fma_f32 v[84:85], v[108:109], v[38:39], v[84:85] op_sel:[1,0,0] op_sel_hi:[1,1,1]
    v_pk_fma_f32 v[84:85], v[110:111], v[40:41], v[84:85] op_sel:[0,0,0] op_sel_hi:[0,1,1]
    v_pk_fma_f32 v[84:85], v[110:111], v[42:43], v[84:85] op_sel:[1,0,0] op_sel_hi:[1,1,1]
    buffer_load_dwordx4 v[108:111], v0, s[8:11], s40 offen offset:256 nt
    s_waitcnt vmcnt(15)
    v_cvt_f32_i32 v112, v112
    v_cvt_f32_i32 v113, v113
    v_cvt_f32_i32 v114, v114
    v_cvt_f32_i32 v115, v115
    v_pk_fma_f32 v[84:85], v[112:113], v[44:45], v[84:85] op_sel:[0,0,0] op_sel_hi:[0,1,1]
    v_pk_fma_f32 v[84:85], v[112:113], v[46:47], v[84:85] op_sel:[1,0,0] op_sel_hi:[1,1,1]
    v_pk_fma_f32 v[84:85], v[114:115], v[48:49], v[84:85] op_sel:[0,0,0] op_sel_hi:[0,1,1]
    v_pk_fma_f32 v[84:85], v[114:115], v[50:51], v[84:85] op_sel:[1,0,0] op_sel_hi:[1,1,1]
    buffer_load_dwordx4 v[112:115], v0, s[8:11], s40 offen offset:384 nt
    s_add_u32 s40, s40, s69
    s_waitcnt vmcnt(15)
    v_cvt_f32_i32 v116, v116
    v_cvt_f32_i32 v117, v117
    v_cvt_f32_i32 v118, v118
    v_cvt_f32_i32 v119, v119
    v_pk_mul_f32 v[86:87], v[116:117], v[20:21] op_sel:[0,0] op_sel_hi:[0,1]
    v_pk_fma_f32 v[86:87], v[116:117], v[22:23], v[86:87] op_sel:[1,0,0] op_sel_hi:[1,1,1]
    v_pk_fma_f32 v[86:87], v[118:119], v[24:25], v[86:87] op_sel:[0,0,0] op_sel_hi:[0,1,1]
    v_pk_fma_f32 v[86:87], v[118:119], v[26:27], v[86:87] op_sel:[1,0,0] op_sel_hi:[1,1,1]
    buffer_load_dwordx4 v[116:119], v0, s[8:11], s40 offen offset:0 nt
    s_waitcnt vmcnt(15)
    v_cvt_f32_i32 v120, v120
    v_cvt_f32_i32 v121, v121
    v_cvt_f32_i32 v122, v122
    v_cvt_f32_i32 v123, v123
    v_pk_fma_f32 v[86:87], v[120:121], v[28:29], v[86:87] op_sel:[0,0,0] op_sel_hi:[0,1,1]
    v_pk_fma_f32 v[86:87], v[120:121], v[30:31], v[86:87] op_sel:[1,0,0] op_sel_hi:[1,1,1]
    v_pk_fma_f32 v[86:87], v[122:123], v[32:33], v[86:87] op_sel:[0,0,0] op_sel_hi:[0,1,1]
    v_pk_fma_f32 v[86:87], v[122:123], v[34:35], v[86:87] op_sel:[1,0,0] op_sel_hi:[1,1,1]
    buffer_load_dwordx4 v[120:123], v0, s[8:11], s40 offen offset:128 nt
    s_waitcnt vmcnt(15)
    v_cvt_f32_i32 v124, v124
    v_cvt_f32_i32 v125, v125
    v_cvt_f32_i32 v126, v126
    v_cvt_f32_i32 v127, v127
    v_pk_fma_f32 v[86:87], v[124:125], v[36:37], v[86:87] op_sel:[0,0,0] op_sel_hi:[0,1,1]
    v_pk_fma_f32 v[86:87], v[124:125], v[38:39], v[86:87] op_sel:[1,0,0] op_sel_hi:[1,1,1]
    v_pk_fma_f32 v[86:87], v[126:127], v[40:41], v[86:87] op_sel:[0,0,0] op_sel_hi:[0,1,1]
    v_pk_fma_f32 v[86:87], v[126:127], v[42:43], v[86:87] op_sel:[1,0,0] op_sel_hi:[1,1,1]
    buffer_load_dwordx4 v[124:127], v0, s[8:11], s40 offen offset:256 nt
    s_waitcnt vmcnt(15)
    v_cvt_f32_i32 v128, v128
    v_cvt_f32_i32 v129, v129
    v_cvt_f32_i32 v130, v130
    v_cvt_f32_i32 v131, v131
    v_pk_fma_f32 v[86:87], v[128:129], v[44:45], v[86:87] op_sel:[0,0,0] op_sel_hi:[0,1,1]
    v_pk_fma_f32 v[86:87], v[128:129], v[46:47], v[86:87] op_sel:[1,0,0] op_sel_hi:[1,1,1]
    v_pk_fma_f32 v[86:87], v[130:131], v[48:49], v[86:87] op_sel:[0,0,0] op_sel_hi:[0,1,1]
    v_pk_fma_f32 v[86:87], v[130:131], v[50:51], v[86:87] op_sel:[1,0,0] op_sel_hi:[1,1,1]
    buffer_load_dwordx4 v[128:131], v0, s[8:11], s40 offen offset:384 nt
    s_add_u32 s40, s40, s69
    v_add_f32_dpp v84, v84, v84 row_half_mirror row_mask:0xf bank_mask:0x5
    v_add_f32_dpp v85, v85, v85 row_half_mirror row_mask:0xf bank_mask:0x5
    s_nop 0
    v_add_f32_dpp v84, v86, v86 row_half_mirror row_mask:0xf bank_mask:0xa
    v_add_f32_dpp v85, v87, v87 row_half_mirror row_mask:0xf bank_mask:0xa
    s_barrier
    s_waitcnt vmcnt(15)
    v_cvt_f32_i32 v132, v132
    v_cvt_f32_i32 v133, v133
    v_cvt_f32_i32 v134, v134
    v_cvt_f32_i32 v135, v135
    v_pk_mul_f32 v[88:89], v[132:133], v[20:21] op_sel:[0,0] op_sel_hi:[0,1]
    v_pk_fma_f32 v[88:89], v[132:133], v[22:23], v[88:89] op_sel:[1,0,0] op_sel_hi:[1,1,1]
    v_pk_fma_f32 v[88:89], v[134:135], v[24:25], v[88:89] op_sel:[0,0,0] op_sel_hi:[0,1,1]
    v_pk_fma_f32 v[88:89], v[134:135], v[26:27], v[88:89] op_sel:[1,0,0] op_sel_hi:[1,1,1]
    buffer_load_dwordx4 v[132:135], v0, s[8:11], s40 offen offset:0 nt
    s_waitcnt vmcnt(15)
    v_cvt_f32_i32 v136, v136
    v_cvt_f32_i32 v137, v137
    v_cvt_f32_i32 v138, v138
    v_cvt_f32_i32 v139, v139
    v_pk_fma_f32 v[88:89], v[136:137], v[28:29], v[88:89] op_sel:[0,0,0] op_sel_hi:[0,1,1]
    v_pk_fma_f32 v[88:89], v[136:137], v[30:31], v[88:89] op_sel:[1,0,0] op_sel_hi:[1,1,1]
    v_pk_fma_f32 v[88:89], v[138:139], v[32:33], v[88:89] op_sel:[0,0,0] op_sel_hi:[0,1,1]
    v_pk_fma_f32 v[88:89], v[138:139], v[34:35], v[88:89] op_sel:[1,0,0] op_sel_hi:[1,1,1]
    buffer_load_dwordx4 v[136:139], v0, s[8:11], s40 offen offset:128 nt
    s_waitcnt vmcnt(15)
    v_cvt_f32_i32 v140, v140
    v_cvt_f32_i32 v141, v141
    v_cvt_f32_i32 v142, v142
    v_cvt_f32_i32 v143, v143
    v_pk_fma_f32 v[88:89], v[140:141], v[36:37], v[88:89] op_sel:[0,0,0] op_sel_hi:[0,1,1]
    v_pk_fma_f32 v[88:89], v[140:141], v[38:39], v[88:89] op_sel:[1,0,0] op_sel_hi:[1,1,1]
    v_pk_fma_f32 v[88:89], v[142:143], v[40:41], v[88:89] op_sel:[0,0,0] op_sel_hi:[0,1,1]
    v_pk_fma_f32 v[88:89], v[142:143], v[42:43], v[88:89] op_sel:[1,0,0] op_sel_hi:[1,1,1]
    buffer_load_dwordx4 v[140:143], v0, s[8:11], s40 offen offset:256 nt
    s_waitcnt vmcnt(15)
    v_cvt_f32_i32 v144, v144
    v_cvt_f32_i32 v145, v145
    v_cvt_f32_i32 v146, v146
    v_cvt_f32_i32 v147, v147
    v_pk_fma_f32 v[88:89], v[144:145], v[44:45], v[88:89] op_sel:[0,0,0] op_sel_hi:[0,1,1]
    v_pk_fma_f32 v[88:89], v[144:145], v[46:47], v[88:89] op_sel:[1,0,0] op_sel_hi:[1,1,1]
    v_pk_fma_f32 v[88:89], v[146:147], v[48:49], v[88:89] op_sel:[0,0,0] op_sel_hi:[0,1,1]
    v_pk_fma_f32 v[88:89], v[146:147], v[50:51], v[88:89] op_sel:[1,0,0] op_sel_hi:[1,1,1]
    buffer_load_dwordx4 v[144:147], v0, s[8:11], s40 offen offset:384 nt
    s_add_u32 s40, s40, s69
    s_waitcnt vmcnt(15)
    v_cvt_f32_i32 v148, v148
    v_cvt_f32_i32 v149, v149
    v_cvt_f32_i32 v150, v150
    v_cvt_f32_i32 v151, v151
    v_pk_mul_f32 v[90:91], v[148:149], v[20:21] op_sel:[0,0] op_sel_hi:[0,1]
    v_pk_fma_f32 v[90:91], v[148:149], v[22:23], v[90:91] op_sel:[1,0,0] op_sel_hi:[1,1,1]
    v_pk_fma_f32 v[90:91], v[150:151], v[24:25], v[90:91] op_sel:[0,0,0] op_sel_hi:[0,1,1]
    v_pk_fma_f32 v[90:91], v[150:151], v[26:27], v[90:91] op_sel:[1,0,0] op_sel_hi:[1,1,1]
    buffer_load_dwordx4 v[148:151], v0, s[8:11], s40 offen offset:0 nt
    s_waitcnt vmcnt(15)
    v_cvt_f32_i32 v152, v152
    v_cvt_f32_i32 v153, v153
    v_cvt_f32_i32 v154, v154
    v_cvt_f32_i32 v155, v155
    v_pk_fma_f32 v[90:91], v[152:153], v[28:29], v[90:91] op_sel:[0,0,0] op_sel_hi:[0,1,1]
    v_pk_fma_f32 v[90:91], v[152:153], v[30:31], v[90:91] op_sel:[1,0,0] op_sel_hi:[1,1,1]
    v_pk_fma_f32 v[90:91], v[154:155], v[32:33], v[90:91] op_sel:[0,0,0] op_sel_hi:[0,1,1]
    v_pk_fma_f32 v[90:91], v[154:155], v[34:35], v[90:91] op_sel:[1,0,0] op_sel_hi:[1,1,1]
    buffer_load_dwordx4 v[152:155], v0, s[8:11], s40 offen offset:128 nt
    s_waitcnt vmcnt(15)
    v_cvt_f32_i32 v156, v156
    v_cvt_f32_i32 v157, v157
    v_cvt_f32_i32 v158, v158
    v_cvt_f32_i32 v159, v159
    v_pk_fma_f32 v[90:91], v[156:157], v[36:37], v[90:91] op_sel:[0,0,0] op_sel_hi:[0,1,1]
    v_pk_fma_f32 v[90:91], v[156:157], v[38:39], v[90:91] op_sel:[1,0,0] op_sel_hi:[1,1,1]
    v_pk_fma_f32 v[90:91], v[158:159], v[40:41], v[90:91] op_sel:[0,0,0] op_sel_hi:[0,1,1]
    v_pk_fma_f32 v[90:91], v[158:159], v[42:43], v[90:91] op_sel:[1,0,0] op_sel_hi:[1,1,1]
    buffer_load_dwordx4 v[156:159], v0, s[8:11], s40 offen offset:256 nt
    s_waitcnt vmcnt(15)
    v_cvt_f32_i32 v160, v160
    v_cvt_f32_i32 v161, v161
    v_cvt_f32_i32 v162, v162
    v_cvt_f32_i32 v163, v163
    v_pk_fma_f32 v[90:91], v[160:161], v[44:45], v[90:91] op_sel:[0,0,0] op_sel_hi:[0,1,1]
    v_pk_fma_f32 v[90:91], v[160:161], v[46:47], v[90:91] op_sel:[1,0,0] op_sel_hi:[1,1,1]
    v_pk_fma_f32 v[90:91], v[162:163], v[48:49], v[90:91] op_sel:[0,0,0] op_sel_hi:[0,1,1]
    v_pk_fma_f32 v[90:91], v[162:163], v[50:51], v[90:91] op_sel:[1,0,0] op_sel_hi:[1,1,1]
    buffer_load_dwordx4 v[160:163], v0, s[8:11], s40 offen offset:384 nt
    s_add_u32 s40, s40, s69
    v_add_f32_dpp v88, v88, v88 row_half_mirror row_mask:0xf bank_mask:0x5
    v_add_f32_dpp v89, v89, v89 row_half_mirror row_mask:0xf bank_mask:0x5
    s_nop 0
    v_add_f32_dpp v88, v90, v90 row_half_mirror row_mask:0xf bank_mask:0xa
    v_add_f32_dpp v89, v91, v91 row_half_mirror row_mask:0xf bank_mask:0xa
    v_cndmask_b32 v6, v88, v84, s[44:45]
    v_cndmask_b32 v88, v84, v88, s[44:45]
    v_cndmask_b32 v7, v89, v85, s[44:45]
    v_cndmask_b32 v89, v85, v89, s[44:45]
    v_add_f32_dpp v84, v6, v88 quad_perm:[2,3,0,1] row_mask:0xf bank_mask:0xf
    s_nop 0
    v_add_f32_dpp v85, v7, v89 quad_perm:[2,3,0,1] row_mask:0xf bank_mask:0xf
    s_barrier
    s_waitcnt vmcnt(15)
    s_cmp_lt_u32 s43, s85
    s_cbranch_scc1 L_nt8l
    v_mov_b32 v19, 1
    s_mov_b64 exec, 1
    v_readfirstlane_b32 s58, v170
    s_nop 3
    s_cmp_lg_u32 s58, 0
    s_cbranch_scc1 L_fo8l
    v_mov_b32 v170, 1
    buffer_atomic_add v170, v5, s[4:7], 0 offen offset:4 sc0
    s_waitcnt vmcnt(0)
    v_readfirstlane_b32 s58, v170
    s_nop 3
    s_cmp_lg_u32 s58, 0
    s_cbranch_scc1 L_fs8l
    s_mov_b64 exec, -1
    v_mul_u32_u24 v6, 4096, v18
    s_mov_b32 s58, 12582912
    buffer_store_dword v5, v6, s[36:39], s58 offen sc1
    s_mov_b32 s58, 12845056
    buffer_store_dword v5, v6, s[36:39], s58 offen sc1
    s_waitcnt vmcnt(0)
    s_mov_b64 exec, 1
    v_mov_b32 v170, 3
    buffer_store_dword v170, v5, s[4:7], 0 offen sc1
    s_waitcnt vmcnt(0)
    s_branch L_fo8l
    s_nop 4
L_fs8l:
    buffer_load_dword v170, v5, s[4:7], 0 offen sc1
    s_waitcnt vmcnt(0)
    v_readfirstlane_b32 s58, v170
    s_nop 3
    s_cmp_eq_u32 s58, 0
    s_cbranch_scc1 L_fs8l
    s_nop 4
L_fo8l:
    s_cmp_lg_u32 s43, 3
    s_cbranch_scc1 L_nd8l
    v_readfirstlane_b32 s58, v170
    s_getreg_b32 s59, hwreg(HW_REG_XCC_ID, 2, 1)
    s_nop 2
    s_sub_u32 s58, s58, 1
    s_xor_b32 s62, s58, s59
    s_and_b32 s62, s62, 1
    s_and_b32 s73, s58, 2
    s_cselect_b32 s62, 0, s62
    s_nop 4
L_nd8l:
    s_add_u32 s67, s62, s73
    s_mul_i32 s58, s62, 4096
    s_add_u32 s58, s58, s94
    buffer_atomic_add v19, v5, s[36:39], s58 offen sc0
    s_mov_b64 exec, -1
    s_nop 4
L_nt8l:
    v_cvt_f32_i32 v100, v100
    v_cvt_f32_i32 v101, v101
    v_cvt_f32_i32 v102, v102
    v_cvt_f32_i32 v103, v103
    v_pk_mul_f32 v[92:93], v[100:101], v[20:21] op_sel:[0,0] op_sel_hi:[0,1]
    v_pk_fma_f32 v[92:93], v[100:101], v[22:23], v[92:93] op_sel:[1,0,0] op_sel_hi:[1,1,1]
    v_pk_fma_f32 v[92:93], v[102:103], v[24:25], v[92:93] op_sel:[0,0,0] op_sel_hi:[0,1,1]
    v_pk_fma_f32 v[92:93], v[102:103], v[26:27], v[92:93] op_sel:[1,0,0] op_sel_hi:[1,1,1]
    buffer_load_dwordx4 v[100:103], v0, s[12:15], s41 offen offset:0 nt
    s_waitcnt vmcnt(15)
    v_cvt_f32_i32 v104, v104
    v_cvt_f32_i32 v105, v105
    v_cvt_f32_i32 v106, v106
    v_cvt_f32_i32 v107, v107
    v_pk_fma_f32 v[92:93], v[104:105], v[28:29], v[92:93] op_sel:[0,0,0] op_sel_hi:[0,1,1]
    v_pk_fma_f32 v[92:93], v[104:105], v[30:31], v[92:93] op_sel:[1,0,0] op_sel_hi:[1,1,1]
    v_pk_fma_f32 v[92:93], v[106:107], v[32:33], v[92:93] op_sel:[0,0,0] op_sel_hi:[0,1,1]
    v_pk_fma_f32 v[92:93], v[106:107], v[34:35], v[92:93] op_sel:[1,0,0] op_sel_hi:[1,1,1]
    buffer_load_dwordx4 v[104:107], v0, s[12:15], s41 offen offset:128 nt
    s_waitcnt vmcnt(15)
    v_cvt_f32_i32 v108, v108
    v_cvt_f32_i32 v109, v109
    v_cvt_f32_i32 v110, v110
    v_cvt_f32_i32 v111, v111
    v_pk_fma_f32 v[92:93], v[108:109], v[36:37], v[92:93] op_sel:[0,0,0] op_sel_hi:[0,1,1]
    v_pk_fma_f32 v[92:93], v[108:109], v[38:39], v[92:93] op_sel:[1,0,0] op_sel_hi:[1,1,1]
    v_pk_fma_f32 v[92:93], v[110:111], v[40:41], v[92:93] op_sel:[0,0,0] op_sel_hi:[0,1,1]
    v_pk_fma_f32 v[92:93], v[110:111], v[42:43], v[92:93] op_sel:[1,0,0] op_sel_hi:[1,1,1]
    buffer_load_dwordx4 v[108:111], v0, s[12:15], s41 offen offset:256 nt
    s_waitcnt vmcnt(15)
    v_cvt_f32_i32 v112, v112
    v_cvt_f32_i32 v113, v113
    v_cvt_f32_i32 v114, v114
    v_cvt_f32_i32 v115, v115
    v_pk_fma_f32 v[92:93], v[112:113], v[44:45], v[92:93] op_sel:[0,0,0] op_sel_hi:[0,1,1]
    v_pk_fma_f32 v[92:93], v[112:113], v[46:47], v[92:93] op_sel:[1,0,0] op_sel_hi:[1,1,1]
    v_pk_fma_f32 v[92:93], v[114:115], v[48:49], v[92:93] op_sel:[0,0,0] op_sel_hi:[0,1,1]
    v_pk_fma_f32 v[92:93], v[114:115], v[50:51], v[92:93] op_sel:[1,0,0] op_sel_hi:[1,1,1]
    buffer_load_dwordx4 v[112:115], v0, s[12:15], s41 offen offset:384 nt
    s_add_u32 s41, s41, s69
    s_waitcnt vmcnt(15)
    v_cvt_f32_i32 v116, v116
    v_cvt_f32_i32 v117, v117
    v_cvt_f32_i32 v118, v118
    v_cvt_f32_i32 v119, v119
    v_pk_mul_f32 v[94:95], v[116:117], v[20:21] op_sel:[0,0] op_sel_hi:[0,1]
    v_pk_fma_f32 v[94:95], v[116:117], v[22:23], v[94:95] op_sel:[1,0,0] op_sel_hi:[1,1,1]
    v_pk_fma_f32 v[94:95], v[118:119], v[24:25], v[94:95] op_sel:[0,0,0] op_sel_hi:[0,1,1]
    v_pk_fma_f32 v[94:95], v[118:119], v[26:27], v[94:95] op_sel:[1,0,0] op_sel_hi:[1,1,1]
    buffer_load_dwordx4 v[116:119], v0, s[12:15], s41 offen offset:0 nt
    s_waitcnt vmcnt(15)
    v_cvt_f32_i32 v120, v120
    v_cvt_f32_i32 v121, v121
    v_cvt_f32_i32 v122, v122
    v_cvt_f32_i32 v123, v123
    v_pk_fma_f32 v[94:95], v[120:121], v[28:29], v[94:95] op_sel:[0,0,0] op_sel_hi:[0,1,1]
    v_pk_fma_f32 v[94:95], v[120:121], v[30:31], v[94:95] op_sel:[1,0,0] op_sel_hi:[1,1,1]
    v_pk_fma_f32 v[94:95], v[122:123], v[32:33], v[94:95] op_sel:[0,0,0] op_sel_hi:[0,1,1]
    v_pk_fma_f32 v[94:95], v[122:123], v[34:35], v[94:95] op_sel:[1,0,0] op_sel_hi:[1,1,1]
    buffer_load_dwordx4 v[120:123], v0, s[12:15], s41 offen offset:128 nt
    s_waitcnt vmcnt(15)
    v_cvt_f32_i32 v124, v124
    v_cvt_f32_i32 v125, v125
    v_cvt_f32_i32 v126, v126
    v_cvt_f32_i32 v127, v127
    v_pk_fma_f32 v[94:95], v[124:125], v[36:37], v[94:95] op_sel:[0,0,0] op_sel_hi:[0,1,1]
    v_pk_fma_f32 v[94:95], v[124:125], v[38:39], v[94:95] op_sel:[1,0,0] op_sel_hi:[1,1,1]
    v_pk_fma_f32 v[94:95], v[126:127], v[40:41], v[94:95] op_sel:[0,0,0] op_sel_hi:[0,1,1]
    v_pk_fma_f32 v[94:95], v[126:127], v[42:43], v[94:95] op_sel:[1,0,0] op_sel_hi:[1,1,1]
    buffer_load_dwordx4 v[124:127], v0, s[12:15], s41 offen offset:256 nt
    s_waitcnt vmcnt(15)
    v_cvt_f32_i32 v128, v128
    v_cvt_f32_i32 v129, v129
    v_cvt_f32_i32 v130, v130
    v_cvt_f32_i32 v131, v131
    v_pk_fma_f32 v[94:95], v[128:129], v[44:45], v[94:95] op_sel:[0,0,0] op_sel_hi:[0,1,1]
    v_pk_fma_f32 v[94:95], v[128:129], v[46:47], v[94:95] op_sel:[1,0,0] op_sel_hi:[1,1,1]
    v_pk_fma_f32 v[94:95], v[130:131], v[48:49], v[94:95] op_sel:[0,0,0] op_sel_hi:[0,1,1]
    v_pk_fma_f32 v[94:95], v[130:131], v[50:51], v[94:95] op_sel:[1,0,0] op_sel_hi:[1,1,1]
    buffer_load_dwordx4 v[128:131], v0, s[12:15], s41 offen offset:384 nt
    s_add_u32 s41, s41, s69
    v_add_f32_dpp v92, v92, v92 row_half_mirror row_mask:0xf bank_mask:0x5
    v_add_f32_dpp v93, v93, v93 row_half_mirror row_mask:0xf bank_mask:0x5
    s_nop 0
    v_add_f32_dpp v92, v94, v94 row_half_mirror row_mask:0xf bank_mask:0xa
    v_add_f32_dpp v93, v95, v95 row_half_mirror row_mask:0xf bank_mask:0xa
    s_barrier
    s_waitcnt vmcnt(15)
    v_cvt_f32_i32 v132, v132
    v_cvt_f32_i32 v133, v133
    v_cvt_f32_i32 v134, v134
    v_cvt_f32_i32 v135, v135
    v_pk_mul_f32 v[96:97], v[132:133], v[20:21] op_sel:[0,0] op_sel_hi:[0,1]
    v_pk_fma_f32 v[96:97], v[132:133], v[22:23], v[96:97] op_sel:[1,0,0] op_sel_hi:[1,1,1]
    v_pk_fma_f32 v[96:97], v[134:135], v[24:25], v[96:97] op_sel:[0,0,0] op_sel_hi:[0,1,1]
    v_pk_fma_f32 v[96:97], v[134:135], v[26:27], v[96:97] op_sel:[1,0,0] op_sel_hi:[1,1,1]
    buffer_load_dwordx4 v[132:135], v0, s[12:15], s41 offen offset:0 nt
    s_waitcnt vmcnt(15)
    v_cvt_f32_i32 v136, v136
    v_cvt_f32_i32 v137, v137
    v_cvt_f32_i32 v138, v138
    v_cvt_f32_i32 v139, v139
    v_pk_fma_f32 v[96:97], v[136:137], v[28:29], v[96:97] op_sel:[0,0,0] op_sel_hi:[0,1,1]
    v_pk_fma_f32 v[96:97], v[136:137], v[30:31], v[96:97] op_sel:[1,0,0] op_sel_hi:[1,1,1]
    v_pk_fma_f32 v[96:97], v[138:139], v[32:33], v[96:97] op_sel:[0,0,0] op_sel_hi:[0,1,1]
    v_pk_fma_f32 v[96:97], v[138:139], v[34:35], v[96:97] op_sel:[1,0,0] op_sel_hi:[1,1,1]
    buffer_load_dwordx4 v[136:139], v0, s[12:15], s41 offen offset:128 nt
    s_waitcnt vmcnt(15)
    v_cvt_f32_i32 v140, v140
    v_cvt_f32_i32 v141, v141
    v_cvt_f32_i32 v142, v142
    v_cvt_f32_i32 v143, v143
    v_pk_fma_f32 v[96:97], v[140:141], v[36:37], v[96:97] op_sel:[0,0,0] op_sel_hi:[0,1,1]
    v_pk_fma_f32 v[96:97], v[140:141], v[38:39], v[96:97] op_sel:[1,0,0] op_sel_hi:[1,1,1]
    v_pk_fma_f32 v[96:97], v[142:143], v[40:41], v[96:97] op_sel:[0,0,0] op_sel_hi:[0,1,1]
    v_pk_fma_f32 v[96:97], v[142:143], v[42:43], v[96:97] op_sel:[1,0,0] op_sel_hi:[1,1,1]
    buffer_load_dwordx4 v[140:143], v0, s[12:15], s41 offen offset:256 nt
    s_waitcnt vmcnt(15)
    v_cvt_f32_i32 v144, v144
    v_cvt_f32_i32 v145, v145
    v_cvt_f32_i32 v146, v146
    v_cvt_f32_i32 v147, v147
    v_pk_fma_f32 v[96:97], v[144:145], v[44:45], v[96:97] op_sel:[0,0,0] op_sel_hi:[0,1,1]
    v_pk_fma_f32 v[96:97], v[144:145], v[46:47], v[96:97] op_sel:[1,0,0] op_sel_hi:[1,1,1]
    v_pk_fma_f32 v[96:97], v[146:147], v[48:49], v[96:97] op_sel:[0,0,0] op_sel_hi:[0,1,1]
    v_pk_fma_f32 v[96:97], v[146:147], v[50:51], v[96:97] op_sel:[1,0,0] op_sel_hi:[1,1,1]
    buffer_load_dwordx4 v[144:147], v0, s[12:15], s41 offen offset:384 nt
    s_add_u32 s41, s41, s69
    s_waitcnt vmcnt(15)
    v_cvt_f32_i32 v148, v148
    v_cvt_f32_i32 v149, v149
    v_cvt_f32_i32 v150, v150
    v_cvt_f32_i32 v151, v151
    v_pk_mul_f32 v[98:99], v[148:149], v[20:21] op_sel:[0,0] op_sel_hi:[0,1]
    v_pk_fma_f32 v[98:99], v[148:149], v[22:23], v[98:99] op_sel:[1,0,0] op_sel_hi:[1,1,1]
    v_pk_fma_f32 v[98:99], v[150:151], v[24:25], v[98:99] op_sel:[0,0,0] op_sel_hi:[0,1,1]
    v_pk_fma_f32 v[98:99], v[150:151], v[26:27], v[98:99] op_sel:[1,0,0] op_sel_hi:[1,1,1]
    buffer_load_dwordx4 v[148:151], v0, s[12:15], s41 offen offset:0 nt
    s_waitcnt vmcnt(15)
    v_cvt_f32_i32 v152, v152
    v_cvt_f32_i32 v153, v153
    v_cvt_f32_i32 v154, v154
    v_cvt_f32_i32 v155, v155
    v_pk_fma_f32 v[98:99], v[152:153], v[28:29], v[98:99] op_sel:[0,0,0] op_sel_hi:[0,1,1]
    v_pk_fma_f32 v[98:99], v[152:153], v[30:31], v[98:99] op_sel:[1,0,0] op_sel_hi:[1,1,1]
    v_pk_fma_f32 v[98:99], v[154:155], v[32:33], v[98:99] op_sel:[0,0,0] op_sel_hi:[0,1,1]
    v_pk_fma_f32 v[98:99], v[154:155], v[34:35], v[98:99] op_sel:[1,0,0] op_sel_hi:[1,1,1]
    buffer_load_dwordx4 v[152:155], v0, s[12:15], s41 offen offset:128 nt
    s_waitcnt vmcnt(15)
    v_cvt_f32_i32 v156, v156
    v_cvt_f32_i32 v157, v157
    v_cvt_f32_i32 v158, v158
    v_cvt_f32_i32 v159, v159
    v_pk_fma_f32 v[98:99], v[156:157], v[36:37], v[98:99] op_sel:[0,0,0] op_sel_hi:[0,1,1]
    v_pk_fma_f32 v[98:99], v[156:157], v[38:39], v[98:99] op_sel:[1,0,0] op_sel_hi:[1,1,1]
    v_pk_fma_f32 v[98:99], v[158:159], v[40:41], v[98:99] op_sel:[0,0,0] op_sel_hi:[0,1,1]
    v_pk_fma_f32 v[98:99], v[158:159], v[42:43], v[98:99] op_sel:[1,0,0] op_sel_hi:[1,1,1]
    buffer_load_dwordx4 v[156:159], v0, s[12:15], s41 offen offset:256 nt
    s_waitcnt vmcnt(15)
    v_cvt_f32_i32 v160, v160
    v_cvt_f32_i32 v161, v161
    v_cvt_f32_i32 v162, v162
    v_cvt_f32_i32 v163, v163
    v_pk_fma_f32 v[98:99], v[160:161], v[44:45], v[98:99] op_sel:[0,0,0] op_sel_hi:[0,1,1]
    v_pk_fma_f32 v[98:99], v[160:161], v[46:47], v[98:99] op_sel:[1,0,0] op_sel_hi:[1,1,1]
    v_pk_fma_f32 v[98:99], v[162:163], v[48:49], v[98:99] op_sel:[0,0,0] op_sel_hi:[0,1,1]
    v_pk_fma_f32 v[98:99], v[162:163], v[50:51], v[98:99] op_sel:[1,0,0] op_sel_hi:[1,1,1]
    buffer_load_dwordx4 v[160:163], v0, s[12:15], s41 offen offset:384 nt
    s_add_u32 s41, s41, s69
    v_add_f32_dpp v96, v96, v96 row_half_mirror row_mask:0xf bank_mask:0x5
    v_add_f32_dpp v97, v97, v97 row_half_mirror row_mask:0xf bank_mask:0x5
    s_nop 0
    v_add_f32_dpp v96, v98, v98 row_half_mirror row_mask:0xf bank_mask:0xa
    v_add_f32_dpp v97, v99, v99 row_half_mirror row_mask:0xf bank_mask:0xa
    v_cndmask_b32 v6, v96, v92, s[44:45]
    v_cndmask_b32 v96, v92, v96, s[44:45]
    v_cndmask_b32 v7, v97, v93, s[44:45]
    v_cndmask_b32 v97, v93, v97, s[44:45]
    v_add_f32_dpp v92, v6, v96 quad_perm:[2,3,0,1] row_mask:0xf bank_mask:0xf
    s_nop 0
    v_add_f32_dpp v93, v7, v97 quad_perm:[2,3,0,1] row_mask:0xf bank_mask:0xf
    v_cndmask_b32 v6, v92, v84, s[46:47]
    v_cndmask_b32 v92, v84, v92, s[46:47]
    v_cndmask_b32 v7, v93, v85, s[46:47]
    v_cndmask_b32 v93, v85, v93, s[46:47]
    v_add_f32_dpp v84, v6, v92 quad_perm:[1,0,3,2] row_mask:0xf bank_mask:0xf
    s_nop 0
    v_add_f32_dpp v85, v7, v93 quad_perm:[1,0,3,2] row_mask:0xf bank_mask:0xf
    s_barrier
    s_waitcnt lgkmcnt(0)
    v_mov_b32 v6, v84
    v_mov_b32 v7, v85
    v_lshlrev_b32 v12, 16, v12
    v_lshlrev_b32 v13, 16, v13
    v_permlane32_swap_b32 v6, v7
    v_max_f32 v6, v6, v7
    v_mov_b32 v7, v6
    s_nop 1
    v_permlane16_swap_b32 v6, v7
    v_max_f32 v6, v6, v7
    s_nop 1
    v_max_f32_dpp v6, v6, v6 row_ror:8 row_mask:0xf bank_mask:0xf
    s_nop 1
    v_max_f32_dpp v6, v6, v6 row_ror:4 row_mask:0xf bank_mask:0xf
    s_nop 1
    v_max_f32_dpp v6, v6, v6 row_ror:2 row_mask:0xf bank_mask:0xf
    s_nop 1
    v_max_f32_dpp v6, v6, v6 row_ror:1 row_mask:0xf bank_mask:0xf
    v_max_f32 v6, v6, v4
    v_sub_f32 v7, v4, v6
    v_exp_f32 v7, v7
    v_mov_b32 v4, v6
    v_readlane_b32 s48, v6, 0
    v_readlane_b32 s49, v6, 32
    v_readlane_b32 s50, v7, 0
    v_readlane_b32 s51, v7, 32
    v_subrev_f32 v14, s48, v84
    v_subrev_f32 v15, s49, v85
    v_exp_f32 v14, v14
    v_exp_f32 v15, v15
    v_pk_mul_f32 v[10:11], v[10:11], s[50:51]
    v_pk_mul_f32 v[16:17], v[14:15], v[12:13] op_sel:[0,0] op_sel_hi:[1,0]
    v_pk_fma_f32 v[8:9], v[8:9], s[50:51], v[14:15]
    ds_write_b64 v2, v[16:17]
    v_pk_fma_f32 v[10:11], v[16:17], v[12:13], v[10:11] op_sel:[0,1,0] op_sel_hi:[1,1,1]
    ds_read_b128 v[84:87], v3 offset:0
    ds_read_b128 v[88:91], v3 offset:16
    ds_read_b128 v[92:95], v3 offset:32
    ds_read_b128 v[96:99], v3 offset:48
    v_pk_mul_f32 v[52:53], v[52:53], s[50:51]
    v_pk_mul_f32 v[54:55], v[54:55], s[50:51]
    v_pk_mul_f32 v[56:57], v[56:57], s[50:51]
    v_pk_mul_f32 v[58:59], v[58:59], s[50:51]
    v_pk_mul_f32 v[60:61], v[60:61], s[50:51]
    v_pk_mul_f32 v[62:63], v[62:63], s[50:51]
    v_pk_mul_f32 v[64:65], v[64:65], s[50:51]
    v_pk_mul_f32 v[66:67], v[66:67], s[50:51]
    v_pk_mul_f32 v[68:69], v[68:69], s[50:51]
    v_pk_mul_f32 v[70:71], v[70:71], s[50:51]
    v_pk_mul_f32 v[72:73], v[72:73], s[50:51]
    v_pk_mul_f32 v[74:75], v[74:75], s[50:51]
    v_pk_mul_f32 v[76:77], v[76:77], s[50:51]
    v_pk_mul_f32 v[78:79], v[78:79], s[50:51]
    v_pk_mul_f32 v[80:81], v[80:81], s[50:51]
    v_pk_mul_f32 v[82:83], v[82:83], s[50:51]
    s_waitcnt lgkmcnt(0)
    s_waitcnt vmcnt(15)
    s_cmp_lt_u32 s43, s85
    s_cbranch_scc1 L_np8
    s_mov_b64 exec, 1
    v_lshl_add_u32 v19, v19, 2, s67
    ds_write_b32 v5, v19 offset:6208
    s_mov_b64 exec, -1
    s_waitcnt lgkmcnt(0)
    s_nop 4
L_np8:
    v_cvt_f32_i32 v100, v100
    v_cvt_f32_i32 v101, v101
    v_cvt_f32_i32 v102, v102
    v_cvt_f32_i32 v103, v103
    v_pk_fma_f32 v[52:53], v[100:101], v[84:85], v[52:53] op_sel:[0,0,0] op_sel_hi:[0,1,1]
    v_pk_fma_f32 v[54:55], v[100:101], v[84:85], v[54:55] op_sel:[1,0,0] op_sel_hi:[1,1,1]
    v_pk_fma_f32 v[56:57], v[102:103], v[84:85], v[56:57] op_sel:[0,0,0] op_sel_hi:[0,1,1]
    v_pk_fma_f32 v[58:59], v[102:103], v[84:85], v[58:59] op_sel:[1,0,0] op_sel_hi:[1,1,1]
    buffer_load_dwordx4 v[100:103], v0, s[12:15], s41 offen offset:0 nt
    s_waitcnt vmcnt(15)
    v_cvt_f32_i32 v104, v104
    v_cvt_f32_i32 v105, v105
    v_cvt_f32_i32 v106, v106
    v_cvt_f32_i32 v107, v107
    v_pk_fma_f32 v[60:61], v[104:105], v[84:85], v[60:61] op_sel:[0,0,0] op_sel_hi:[0,1,1]
    v_pk_fma_f32 v[62:63], v[104:105], v[84:85], v[62:63] op_sel:[1,0,0] op_sel_hi:[1,1,1]
    v_pk_fma_f32 v[64:65], v[106:107], v[84:85], v[64:65] op_sel:[0,0,0] op_sel_hi:[0,1,1]
    v_pk_fma_f32 v[66:67], v[106:107], v[84:85], v[66:67] op_sel:[1,0,0] op_sel_hi:[1,1,1]
    buffer_load_dwordx4 v[104:107], v0, s[12:15], s41 offen offset:128 nt
    s_waitcnt vmcnt(15)
    v_cvt_f32_i32 v108, v108
    v_cvt_f32_i32 v109, v109
    v_cvt_f32_i32 v110, v110
    v_cvt_f32_i32 v111, v111
    v_pk_fma_f32 v[68:69], v[108:109], v[84:85], v[68:69] op_sel:[0,0,0] op_sel_hi:[0,1,1]
    v_pk_fma_f32 v[70:71], v[108:109], v[84:85], v[70:71] op_sel:[1,0,0] op_sel_hi:[1,1,1]
    v_pk_fma_f32 v[72:73], v[110:111], v[84:85], v[72:73] op_sel:[0,0,0] op_sel_hi:[0,1,1]
    v_pk_fma_f32 v[74:75], v[110:111], v[84:85], v[74:75] op_sel:[1,0,0] op_sel_hi:[1,1,1]
    buffer_load_dwordx4 v[108:111], v0, s[12:15], s41 offen offset:256 nt
    s_waitcnt vmcnt(15)
    v_cvt_f32_i32 v112, v112
    v_cvt_f32_i32 v113, v113
    v_cvt_f32_i32 v114, v114
    v_cvt_f32_i32 v115, v115
    v_pk_fma_f32 v[76:77], v[112:113], v[84:85], v[76:77] op_sel:[0,0,0] op_sel_hi:[0,1,1]
    v_pk_fma_f32 v[78:79], v[112:113], v[84:85], v[78:79] op_sel:[1,0,0] op_sel_hi:[1,1,1]
    v_pk_fma_f32 v[80:81], v[114:115], v[84:85], v[80:81] op_sel:[0,0,0] op_sel_hi:[0,1,1]
    v_pk_fma_f32 v[82:83], v[114:115], v[84:85], v[82:83] op_sel:[1,0,0] op_sel_hi:[1,1,1]
    buffer_load_dwordx4 v[112:115], v0, s[12:15], s41 offen offset:384 nt
    s_add_u32 s41, s41, s69
    s_waitcnt vmcnt(15)
    v_cvt_f32_i32 v116, v116
    v_cvt_f32_i32 v117, v117
    v_cvt_f32_i32 v118, v118
    v_cvt_f32_i32 v119, v119
    v_pk_fma_f32 v[52:53], v[116:117], v[86:87], v[52:53] op_sel:[0,0,0] op_sel_hi:[0,1,1]
    v_pk_fma_f32 v[54:55], v[116:117], v[86:87], v[54:55] op_sel:[1,0,0] op_sel_hi:[1,1,1]
    v_pk_fma_f32 v[56:57], v[118:119], v[86:87], v[56:57] op_sel:[0,0,0] op_sel_hi:[0,1,1]
    v_pk_fma_f32 v[58:59], v[118:119], v[86:87], v[58:59] op_sel:[1,0,0] op_sel_hi:[1,1,1]
    buffer_load_dwordx4 v[116:119], v0, s[12:15], s41 offen offset:0 nt
    s_waitcnt vmcnt(15)
    v_cvt_f32_i32 v120, v120
    v_cvt_f32_i32 v121, v121
    v_cvt_f32_i32 v122, v122
    v_cvt_f32_i32 v123, v123
    v_pk_fma_f32 v[60:61], v[120:121], v[86:87], v[60:61] op_sel:[0,0,0] op_sel_hi:[0,1,1]
    v_pk_fma_f32 v[62:63], v[120:121], v[86:87], v[62:63] op_sel:[1,0,0] op_sel_hi:[1,1,1]
    v_pk_fma_f32 v[64:65], v[122:123], v[86:87], v[64:65] op_sel:[0,0,0] op_sel_hi:[0,1,1]
    v_pk_fma_f32 v[66:67], v[122:123], v[86:87], v[66:67] op_sel:[1,0,0] op_sel_hi:[1,1,1]
    buffer_load_dwordx4 v[120:123], v0, s[12:15], s41 offen offset:128 nt
    s_waitcnt vmcnt(15)
    v_cvt_f32_i32 v124, v124
    v_cvt_f32_i32 v125, v125
    v_cvt_f32_i32 v126, v126
    v_cvt_f32_i32 v127, v127
    v_pk_fma_f32 v[68:69], v[124:125], v[86:87], v[68:69] op_sel:[0,0,0] op_sel_hi:[0,1,1]
    v_pk_fma_f32 v[70:71], v[124:125], v[86:87], v[70:71] op_sel:[1,0,0] op_sel_hi:[1,1,1]
    v_pk_fma_f32 v[72:73], v[126:127], v[86:87], v[72:73] op_sel:[0,0,0] op_sel_hi:[0,1,1]
    v_pk_fma_f32 v[74:75], v[126:127], v[86:87], v[74:75] op_sel:[1,0,0] op_sel_hi:[1,1,1]
    buffer_load_dwordx4 v[124:127], v0, s[12:15], s41 offen offset:256 nt
    s_waitcnt vmcnt(15)
    v_cvt_f32_i32 v128, v128
    v_cvt_f32_i32 v129, v129
    v_cvt_f32_i32 v130, v130
    v_cvt_f32_i32 v131, v131
    v_pk_fma_f32 v[76:77], v[128:129], v[86:87], v[76:77] op_sel:[0,0,0] op_sel_hi:[0,1,1]
    v_pk_fma_f32 v[78:79], v[128:129], v[86:87], v[78:79] op_sel:[1,0,0] op_sel_hi:[1,1,1]
    v_pk_fma_f32 v[80:81], v[130:131], v[86:87], v[80:81] op_sel:[0,0,0] op_sel_hi:[0,1,1]
    v_pk_fma_f32 v[82:83], v[130:131], v[86:87], v[82:83] op_sel:[1,0,0] op_sel_hi:[1,1,1]
    buffer_load_dwordx4 v[128:131], v0, s[12:15], s41 offen offset:384 nt
    s_add_u32 s41, s41, s69
    s_barrier
    ds_read_b32 v164, v5 offset:6208
    s_memrealtime s[60:61]
    s_waitcnt vmcnt(15)
    v_cvt_f32_i32 v132, v132
    v_cvt_f32_i32 v133, v133
    v_cvt_f32_i32 v134, v134
    v_cvt_f32_i32 v135, v135
    v_pk_fma_f32 v[52:53], v[132:133], v[88:89], v[52:53] op_sel:[0,0,0] op_sel_hi:[0,1,1]
    v_pk_fma_f32 v[54:55], v[132:133], v[88:89], v[54:55] op_sel:[1,0,0] op_sel_hi:[1,1,1]
    v_pk_fma_f32 v[56:57], v[134:135], v[88:89], v[56:57] op_sel:[0,0,0] op_sel_hi:[0,1,1]
    v_pk_fma_f32 v[58:59], v[134:135], v[88:89], v[58:59] op_sel:[1,0,0] op_sel_hi:[1,1,1]
    buffer_load_dwordx4 v[132:135], v0, s[12:15], s41 offen offset:0 nt
    s_waitcnt vmcnt(15)
    v_cvt_f32_i32 v136, v136
    v_cvt_f32_i32 v137, v137
    v_cvt_f32_i32 v138, v138
    v_cvt_f32_i32 v139, v139
    v_pk_fma_f32 v[60:61], v[136:137], v[88:89], v[60:61] op_sel:[0,0,0] op_sel_hi:[0,1,1]
    v_pk_fma_f32 v[62:63], v[136:137], v[88:89], v[62:63] op_sel:[1,0,0] op_sel_hi:[1,1,1]
    v_pk_fma_f32 v[64:65], v[138:139], v[88:89], v[64:65] op_sel:[0,0,0] op_sel_hi:[0,1,1]
    v_pk_fma_f32 v[66:67], v[138:139], v[88:89], v[66:67] op_sel:[1,0,0] op_sel_hi:[1,1,1]
    buffer_load_dwordx4 v[136:139], v0, s[12:15], s41 offen offset:128 nt
    s_waitcnt vmcnt(15)
    v_cvt_f32_i32 v140, v140
    v_cvt_f32_i32 v141, v141
    v_cvt_f32_i32 v142, v142
    v_cvt_f32_i32 v143, v143
    v_pk_fma_f32 v[68:69], v[140:141], v[88:89], v[68:69] op_sel:[0,0,0] op_sel_hi:[0,1,1]
    v_pk_fma_f32 v[70:71], v[140:141], v[88:89], v[70:71] op_sel:[1,0,0] op_sel_hi:[1,1,1]
    v_pk_fma_f32 v[72:73], v[142:143], v[88:89], v[72:73] op_sel:[0,0,0] op_sel_hi:[0,1,1]
    v_pk_fma_f32 v[74:75], v[142:143], v[88:89], v[74:75] op_sel:[1,0,0] op_sel_hi:[1,1,1]
    buffer_load_dwordx4 v[140:143], v0, s[12:15], s41 offen offset:256 nt
    s_waitcnt vmcnt(15)
    v_cvt_f32_i32 v144, v144
    v_cvt_f32_i32 v145, v145
    v_cvt_f32_i32 v146, v146
    v_cvt_f32_i32 v147, v147
    v_pk_fma_f32 v[76:77], v[144:145], v[88:89], v[76:77] op_sel:[0,0,0] op_sel_hi:[0,1,1]
    v_pk_fma_f32 v[78:79], v[144:145], v[88:89], v[78:79] op_sel:[1,0,0] op_sel_hi:[1,1,1]
    v_pk_fma_f32 v[80:81], v[146:147], v[88:89], v[80:81] op_sel:[0,0,0] op_sel_hi:[0,1,1]
    v_pk_fma_f32 v[82:83], v[146:147], v[88:89], v[82:83] op_sel:[1,0,0] op_sel_hi:[1,1,1]
    buffer_load_dwordx4 v[144:147], v0, s[12:15], s41 offen offset:384 nt
    s_add_u32 s41, s41, s69
    s_waitcnt lgkmcnt(0)
    s_sub_u32 s59, s60, s65
    s_mov_b32 s65, s60
    s_add_u32 s91, s70, s59
    s_cmp_lt_u32 s43, 4
    s_cselect_b32 s70, s91, s70
    s_cselect_b32 s59, 0, s59
    s_cmp_eq_u32 s43, 0
    s_cselect_b32 s70, 0, s70
    s_mul_i32 s59, s59, 30
    s_mul_i32 s91, s70, 16
    s_add_i32 s64, s64, 1
    s_cmp_gt_u32 s59, s91
    s_cselect_b32 s64, s64, 0
    s_or_b32 s91, s63, s73
    s_cselect_b32 s64, 0, s64
    s_cmp_ge_i32 s64, 2
    s_cselect_b32 s59, 1, 0
    s_cselect_b32 s64, -1, s64
    s_xor_b32 s62, s62, s59
    s_waitcnt vmcnt(15)
    v_cvt_f32_i32 v148, v148
    v_cvt_f32_i32 v149, v149
    v_cvt_f32_i32 v150, v150
    v_cvt_f32_i32 v151, v151
    v_pk_fma_f32 v[52:53], v[148:149], v[90:91], v[52:53] op_sel:[0,0,0] op_sel_hi:[0,1,1]
    v_pk_fma_f32 v[54:55], v[148:149], v[90:91], v[54:55] op_sel:[1,0,0] op_sel_hi:[1,1,1]
    v_pk_fma_f32 v[56:57], v[150:151], v[90:91], v[56:57] op_sel:[0,0,0] op_sel_hi:[0,1,1]
    v_pk_fma_f32 v[58:59], v[150:151], v[90:91], v[58:59] op_sel:[1,0,0] op_sel_hi:[1,1,1]
    buffer_load_dwordx4 v[148:151], v0, s[12:15], s41 offen offset:0 nt
    s_waitcnt vmcnt(15)
    v_cvt_f32_i32 v152, v152
    v_cvt_f32_i32 v153, v153
    v_cvt_f32_i32 v154, v154
    v_cvt_f32_i32 v155, v155
    v_pk_fma_f32 v[60:61], v[152:153], v[90:91], v[60:61] op_sel:[0,0,0] op_sel_hi:[0,1,1]
    v_pk_fma_f32 v[62:63], v[152:153], v[90:91], v[62:63] op_sel:[1,0,0] op_sel_hi:[1,1,1]
    v_pk_fma_f32 v[64:65], v[154:155], v[90:91], v[64:65] op_sel:[0,0,0] op_sel_hi:[0,1,1]
    v_pk_fma_f32 v[66:67], v[154:155], v[90:91], v[66:67] op_sel:[1,0,0] op_sel_hi:[1,1,1]
    buffer_load_dwordx4 v[152:155], v0, s[12:15], s41 offen offset:128 nt
    s_waitcnt vmcnt(15)
    v_cvt_f32_i32 v156, v156
    v_cvt_f32_i32 v157, v157
    v_cvt_f32_i32 v158, v158
    v_cvt_f32_i32 v159, v159
    v_pk_fma_f32 v[68:69], v[156:157], v[90:91], v[68:69] op_sel:[0,0,0] op_sel_hi:[0,1,1]
    v_pk_fma_f32 v[70:71], v[156:157], v[90:91], v[70:71] op_sel:[1,0,0] op_sel_hi:[1,1,1]
    v_pk_fma_f32 v[72:73], v[158:159], v[90:91], v[72:73] op_sel:[0,0,0] op_sel_hi:[0,1,1]
    v_pk_fma_f32 v[74:75], v[158:159], v[90:91], v[74:75] op_sel:[1,0,0] op_sel_hi:[1,1,1]
    buffer_load_dwordx4 v[156:159], v0, s[12:15], s41 offen offset:256 nt
    s_waitcnt vmcnt(15)
    v_cvt_f32_i32 v160, v160
    v_cvt_f32_i32 v161, v161
    v_cvt_f32_i32 v162, v162
    v_cvt_f32_i32 v163, v163
    v_pk_fma_f32 v[76:77], v[160:161], v[90:91], v[76:77] op_sel:[0,0,0] op_sel_hi:[0,1,1]
    v_pk_fma_f32 v[78:79], v[160:161], v[90:91], v[78:79] op_sel:[1,0,0] op_sel_hi:[1,1,1]
    v_pk_fma_f32 v[80:81], v[162:163], v[90:91], v[80:81] op_sel:[0,0,0] op_sel_hi:[0,1,1]
    v_pk_fma_f32 v[82:83], v[162:163], v[90:91], v[82:83] op_sel:[1,0,0] op_sel_hi:[1,1,1]
    buffer_load_dwordx4 v[160:163], v0, s[12:15], s41 offen offset:384 nt
    s_add_u32 s41, s41, s69
    s_barrier
    s_waitcnt lgkmcnt(0)
    v_readfirstlane_b32 s58, v164
    s_add_u32 s43, s43, 1
    s_nop 2
    s_and_b32 s68, s58, 3
    s_lshr_b32 s58, s58, 2
    s_bfe_u32 s91, s58, 0x10003
    s_add_u32 s91, s91, 2
    s_lshr_b32 s59, s58, 4
    s_lshl_b32 s59, s59, 3
    s_and_b32 s92, s58, 7
    s_add_u32 s59, s59, s92
    s_cmp_ge_u32 s68, 2
    s_cselect_b32 s58, s59, s58
    s_cselect_b32 s68, s91, s68
    s_add_u32 s58, s58, 16
    s_lshr_b32 s59, s43, 1
    s_lshl_b32 s59, s59, 3
    s_and_b32 s93, s43, 1
    s_add_u32 s93, s93, 2
    s_add_u32 s59, s59, s3
    s_cmp_lt_u32 s43, 4
    s_cselect_b32 s58, s59, s58
    s_cselect_b32 s68, s93, s68
    s_and_b32 s66, s68, 1
    s_lshl_b32 s42, s58, 2
    s_sub_i32 s58, s58, 56
    s_max_i32 s58, s58, 0
    s_min_u32 s58, s58, 62
    s_add_u32 s59, s58, 1
    s_nop 3
    v_readlane_b32 s91, v166, s58
    v_readlane_b32 s92, v166, s59
    s_nop 3
    s_sub_u32 s29, s92, s91
    s_cmp_lt_u32 s42, 224
    s_cselect_b32 s91, s42, s91
    s_cselect_b32 s29, 4, s29
    s_cmp_eq_u32 s29, 0
    s_cbranch_scc1 L_last8
    s_bfe_u32 s58, s91, 0x30002
    s_xor_b32 s92, s66, s31
    s_xor_b32 s92, s92, s58
    s_and_b32 s92, s92, 1
    s_lshl_b32 s92, s92, 4
    s_add_u32 s92, s92, s34
    s_lshl_b32 s59, s66, 8
    s_add_u32 s59, s59, s72
    s_cmp_ge_u32 s68, 2
    s_cselect_b32 s92, s59, s92
    s_cselect_b32 s68, 14, 15
    s_lshl_b32 s69, 1, s68
    s_lshl_b32 s95, s58, 12
    s_add_u32 s95, s95, s92
    s_lshr_b32 s59, s91, 5
    s_lshl_b32 s59, s59, 9
    s_add_u32 s95, s95, s59
    s_lshr_b32 s92, s69, 8
    s_and_b32 s59, s91, 3
    s_mul_i32 s59, s59, s92
    s_add_u32 s95, s95, s59
    s_lshl_b32 s58, s29, 1
    s_sub_u32 s58, s58, 1
    v_and_b32 v167, s58, v1
    v_mad_u32_u24 v167, v167, s92, v165
    s_lshl_b32 s59, s69, 1
    s_lshl_b32 s42, s95, 1
    s_cmp_eq_u32 s29, 1
    s_cselect_b32 s24, s12, s8
    s_cselect_b32 s25, s13, s9
    s_cselect_b32 s30, 0, s59
    buffer_load_ushort v168, v167, s[16:19], s42 offen
    buffer_load_ushort v169, v167, s[20:23], s42 offen
    s_lshl_b32 s40, s95, 9
    s_lshl_b32 s41, s95, 9
    s_add_u32 s28, s40, s30
    s_cmp_eq_u32 s29, 4
    s_cbranch_scc1 L_nt8
    s_cmp_lt_u32 s43, s85
    s_cbranch_scc1 L_nt8
    v_mov_b32 v19, 1
    s_mov_b64 exec, 1
    s_add_u32 s67, s62, s73
    s_mul_i32 s58, s62, 4096
    s_add_u32 s58, s58, s94
    buffer_atomic_add v19, v5, s[36:39], s58 offen sc0
    s_mov_b64 exec, -1
    s_nop 4
L_nt8:
    s_waitcnt vmcnt(17)
    v_cvt_f32_i32 v100, v100
    v_cvt_f32_i32 v101, v101
    v_cvt_f32_i32 v102, v102
    v_cvt_f32_i32 v103, v103
    v_pk_fma_f32 v[52:53], v[100:101], v[92:93], v[52:53] op_sel:[0,0,0] op_sel_hi:[0,1,1]
    v_pk_fma_f32 v[54:55], v[100:101], v[92:93], v[54:55] op_sel:[1,0,0] op_sel_hi:[1,1,1]
    v_pk_fma_f32 v[56:57], v[102:103], v[92:93], v[56:57] op_sel:[0,0,0] op_sel_hi:[0,1,1]
    v_pk_fma_f32 v[58:59], v[102:103], v[92:93], v[58:59] op_sel:[1,0,0] op_sel_hi:[1,1,1]
    buffer_load_dwordx4 v[100:103], v0, s[8:11], s40 offen offset:0 nt
    s_waitcnt vmcnt(17)
    v_cvt_f32_i32 v104, v104
    v_cvt_f32_i32 v105, v105
    v_cvt_f32_i32 v106, v106
    v_cvt_f32_i32 v107, v107
    v_pk_fma_f32 v[60:61], v[104:105], v[92:93], v[60:61] op_sel:[0,0,0] op_sel_hi:[0,1,1]
    v_pk_fma_f32 v[62:63], v[104:105], v[92:93], v[62:63] op_sel:[1,0,0] op_sel_hi:[1,1,1]
    v_pk_fma_f32 v[64:65], v[106:107], v[92:93], v[64:65] op_sel:[0,0,0] op_sel_hi:[0,1,1]
    v_pk_fma_f32 v[66:67], v[106:107], v[92:93], v[66:67] op_sel:[1,0,0] op_sel_hi:[1,1,1]
    buffer_load_dwordx4 v[104:107], v0, s[8:11], s40 offen offset:128 nt
    s_waitcnt vmcnt(17)
    v_cvt_f32_i32 v108, v108
    v_cvt_f32_i32 v109, v109
    v_cvt_f32_i32 v110, v110
    v_cvt_f32_i32 v111, v111
    v_pk_fma_f32 v[68:69], v[108:109], v[92:93], v[68:69] op_sel:[0,0,0] op_sel_hi:[0,1,1]
    v_pk_fma_f32 v[70:71], v[108:109], v[92:93], v[70:71] op_sel:[1,0,0] op_sel_hi:[1,1,1]
    v_pk_fma_f32 v[72:73], v[110:111], v[92:93], v[72:73] op_sel:[0,0,0] op_sel_hi:[0,1,1]
    v_pk_fma_f32 v[74:75], v[110:111], v[92:93], v[74:75] op_sel:[1,0,0] op_sel_hi:[1,1,1]
    buffer_load_dwordx4 v[108:111], v0, s[8:11], s40 offen offset:256 nt
    s_waitcnt vmcnt(17)
    v_cvt_f32_i32 v112, v112
    v_cvt_f32_i32 v113, v113
    v_cvt_f32_i32 v114, v114
    v_cvt_f32_i32 v115, v115
    v_pk_fma_f32 v[76:77], v[112:113], v[92:93], v[76:77] op_sel:[0,0,0] op_sel_hi:[0,1,1]
    v_pk_fma_f32 v[78:79], v[112:113], v[92:93], v[78:79] op_sel:[1,0,0] op_sel_hi:[1,1,1]
    v_pk_fma_f32 v[80:81], v[114:115], v[92:93], v[80:81] op_sel:[0,0,0] op_sel_hi:[0,1,1]
    v_pk_fma_f32 v[82:83], v[114:115], v[92:93], v[82:83] op_sel:[1,0,0] op_sel_hi:[1,1,1]
    buffer_load_dwordx4 v[112:115], v0, s[8:11], s40 offen offset:384 nt
    s_add_u32 s40, s40, s69
    s_waitcnt vmcnt(17)
    v_cvt_f32_i32 v116, v116
    v_cvt_f32_i32 v117, v117
    v_cvt_f32_i32 v118, v118
    v_cvt_f32_i32 v119, v119
    v_pk_fma_f32 v[52:53], v[116:117], v[94:95], v[52:53] op_sel:[0,0,0] op_sel_hi:[0,1,1]
    v_pk_fma_f32 v[54:55], v[116:117], v[94:95], v[54:55] op_sel:[1,0,0] op_sel_hi:[1,1,1]
    v_pk_fma_f32 v[56:57], v[118:119], v[94:95], v[56:57] op_sel:[0,0,0] op_sel_hi:[0,1,1]
    v_pk_fma_f32 v[58:59], v[118:119], v[94:95], v[58:59] op_sel:[1,0,0] op_sel_hi:[1,1,1]
    buffer_load_dwordx4 v[116:119], v0, s[8:11], s40 offen offset:0 nt
    s_waitcnt vmcnt(17)
    v_cvt_f32_i32 v120, v120
    v_cvt_f32_i32 v121, v121
    v_cvt_f32_i32 v122, v122
    v_cvt_f32_i32 v123, v123
    v_pk_fma_f32 v[60:61], v[120:121], v[94:95], v[60:61] op_sel:[0,0,0] op_sel_hi:[0,1,1]
    v_pk_fma_f32 v[62:63], v[120:121], v[94:95], v[62:63] op_sel:[1,0,0] op_sel_hi:[1,1,1]
    v_pk_fma_f32 v[64:65], v[122:123], v[94:95], v[64:65] op_sel:[0,0,0] op_sel_hi:[0,1,1]
    v_pk_fma_f32 v[66:67], v[122:123], v[94:95], v[66:67] op_sel:[1,0,0] op_sel_hi:[1,1,1]
    buffer_load_dwordx4 v[120:123], v0, s[8:11], s40 offen offset:128 nt
    s_waitcnt vmcnt(17)
    v_cvt_f32_i32 v124, v124
    v_cvt_f32_i32 v125, v125
    v_cvt_f32_i32 v126, v126
    v_cvt_f32_i32 v127, v127
    v_pk_fma_f32 v[68:69], v[124:125], v[94:95], v[68:69] op_sel:[0,0,0] op_sel_hi:[0,1,1]
    v_pk_fma_f32 v[70:71], v[124:125], v[94:95], v[70:71] op_sel:[1,0,0] op_sel_hi:[1,1,1]
    v_pk_fma_f32 v[72:73], v[126:127], v[94:95], v[72:73] op_sel:[0,0,0] op_sel_hi:[0,1,1]
    v_pk_fma_f32 v[74:75], v[126:127], v[94:95], v[74:75] op_sel:[1,0,0] op_sel_hi:[1,1,1]
    buffer_load_dwordx4 v[124:127], v0, s[8:11], s40 offen offset:256 nt
    s_waitcnt vmcnt(17)
    v_cvt_f32_i32 v128, v128
    v_cvt_f32_i32 v129, v129
    v_cvt_f32_i32 v130, v130
    v_cvt_f32_i32 v131, v131
    v_pk_fma_f32 v[76:77], v[128:129], v[94:95], v[76:77] op_sel:[0,0,0] op_sel_hi:[0,1,1]
    v_pk_fma_f32 v[78:79], v[128:129], v[94:95], v[78:79] op_sel:[1,0,0] op_sel_hi:[1,1,1]
    v_pk_fma_f32 v[80:81], v[130:131], v[94:95], v[80:81] op_sel:[0,0,0] op_sel_hi:[0,1,1]
    v_pk_fma_f32 v[82:83], v[130:131], v[94:95], v[82:83] op_sel:[1,0,0] op_sel_hi:[1,1,1]
    buffer_load_dwordx4 v[128:131], v0, s[8:11], s40 offen offset:384 nt
    s_add_u32 s40, s40, s69
    s_barrier
    s_waitcnt vmcnt(17)
    v_cvt_f32_i32 v132, v132
    v_cvt_f32_i32 v133, v133
    v_cvt_f32_i32 v134, v134
    v_cvt_f32_i32 v135, v135
    v_pk_fma_f32 v[52:53], v[132:133], v[96:97], v[52:53] op_sel:[0,0,0] op_sel_hi:[0,1,1]
    v_pk_fma_f32 v[54:55], v[132:133], v[96:97], v[54:55] op_sel:[1,0,0] op_sel_hi:[1,1,1]
    v_pk_fma_f32 v[56:57], v[134:135], v[96:97], v[56:57] op_sel:[0,0,0] op_sel_hi:[0,1,1]
    v_pk_fma_f32 v[58:59], v[134:135], v[96:97], v[58:59] op_sel:[1,0,0] op_sel_hi:[1,1,1]
    buffer_load_dwordx4 v[132:135], v0, s[24:27], s28 offen offset:0 nt
    s_waitcnt vmcnt(17)
    v_cvt_f32_i32 v136, v136
    v_cvt_f32_i32 v137, v137
    v_cvt_f32_i32 v138, v138
    v_cvt_f32_i32 v139, v139
    v_pk_fma_f32 v[60:61], v[136:137], v[96:97], v[60:61] op_sel:[0,0,0] op_sel_hi:[0,1,1]
    v_pk_fma_f32 v[62:63], v[136:137], v[96:97], v[62:63] op_sel:[1,0,0] op_sel_hi:[1,1,1]
    v_pk_fma_f32 v[64:65], v[138:139], v[96:97], v[64:65] op_sel:[0,0,0] op_sel_hi:[0,1,1]
    v_pk_fma_f32 v[66:67], v[138:139], v[96:97], v[66:67] op_sel:[1,0,0] op_sel_hi:[1,1,1]
    buffer_load_dwordx4 v[136:139], v0, s[24:27], s28 offen offset:128 nt
    s_waitcnt vmcnt(17)
    v_cvt_f32_i32 v140, v140
    v_cvt_f32_i32 v141, v141
    v_cvt_f32_i32 v142, v142
    v_cvt_f32_i32 v143, v143
    v_pk_fma_f32 v[68:69], v[140:141], v[96:97], v[68:69] op_sel:[0,0,0] op_sel_hi:[0,1,1]
    v_pk_fma_f32 v[70:71], v[140:141], v[96:97], v[70:71] op_sel:[1,0,0] op_sel_hi:[1,1,1]
    v_pk_fma_f32 v[72:73], v[142:143], v[96:97], v[72:73] op_sel:[0,0,0] op_sel_hi:[0,1,1]
    v_pk_fma_f32 v[74:75], v[142:143], v[96:97], v[74:75] op_sel:[1,0,0] op_sel_hi:[1,1,1]
    buffer_load_dwordx4 v[140:143], v0, s[24:27], s28 offen offset:256 nt
    s_waitcnt vmcnt(17)
    v_cvt_f32_i32 v144, v144
    v_cvt_f32_i32 v145, v145
    v_cvt_f32_i32 v146, v146
    v_cvt_f32_i32 v147, v147
    v_pk_fma_f32 v[76:77], v[144:145], v[96:97], v[76:77] op_sel:[0,0,0] op_sel_hi:[0,1,1]
    v_pk_fma_f32 v[78:79], v[144:145], v[96:97], v[78:79] op_sel:[1,0,0] op_sel_hi:[1,1,1]
    v_pk_fma_f32 v[80:81], v[146:147], v[96:97], v[80:81] op_sel:[0,0,0] op_sel_hi:[0,1,1]
    v_pk_fma_f32 v[82:83], v[146:147], v[96:97], v[82:83] op_sel:[1,0,0] op_sel_hi:[1,1,1]
    buffer_load_dwordx4 v[144:147], v0, s[24:27], s28 offen offset:384 nt
    s_add_u32 s28, s28, s69
    s_add_u32 s40, s40, s69
    s_waitcnt vmcnt(17)
    v_cvt_f32_i32 v148, v148
    v_cvt_f32_i32 v149, v149
    v_cvt_f32_i32 v150, v150
    v_cvt_f32_i32 v151, v151
    v_pk_fma_f32 v[52:53], v[148:149], v[98:99], v[52:53] op_sel:[0,0,0] op_sel_hi:[0,1,1]
    v_pk_fma_f32 v[54:55], v[148:149], v[98:99], v[54:55] op_sel:[1,0,0] op_sel_hi:[1,1,1]
    v_pk_fma_f32 v[56:57], v[150:151], v[98:99], v[56:57] op_sel:[0,0,0] op_sel_hi:[0,1,1]
    v_pk_fma_f32 v[58:59], v[150:151], v[98:99], v[58:59] op_sel:[1,0,0] op_sel_hi:[1,1,1]
    buffer_load_dwordx4 v[148:151], v0, s[24:27], s28 offen offset:0 nt
    s_waitcnt vmcnt(17)
    v_cvt_f32_i32 v152, v152
    v_cvt_f32_i32 v153, v153
    v_cvt_f32_i32 v154, v154
    v_cvt_f32_i32 v155, v155
    v_pk_fma_f32 v[60:61], v[152:153], v[98:99], v[60:61] op_sel:[0,0,0] op_sel_hi:[0,1,1]
    v_pk_fma_f32 v[62:63], v[152:153], v[98:99], v[62:63] op_sel:[1,0,0] op_sel_hi:[1,1,1]
    v_pk_fma_f32 v[64:65], v[154:155], v[98:99], v[64:65] op_sel:[0,0,0] op_sel_hi:[0,1,1]
    v_pk_fma_f32 v[66:67], v[154:155], v[98:99], v[66:67] op_sel:[1,0,0] op_sel_hi:[1,1,1]
    buffer_load_dwordx4 v[152:155], v0, s[24:27], s28 offen offset:128 nt
    s_waitcnt vmcnt(17)
    v_cvt_f32_i32 v156, v156
    v_cvt_f32_i32 v157, v157
    v_cvt_f32_i32 v158, v158
    v_cvt_f32_i32 v159, v159
    v_pk_fma_f32 v[68:69], v[156:157], v[98:99], v[68:69] op_sel:[0,0,0] op_sel_hi:[0,1,1]
    v_pk_fma_f32 v[70:71], v[156:157], v[98:99], v[70:71] op_sel:[1,0,0] op_sel_hi:[1,1,1]
    v_pk_fma_f32 v[72:73], v[158:159], v[98:99], v[72:73] op_sel:[0,0,0] op_sel_hi:[0,1,1]
    v_pk_fma_f32 v[74:75], v[158:159], v[98:99], v[74:75] op_sel:[1,0,0] op_sel_hi:[1,1,1]
    buffer_load_dwordx4 v[156:159], v0, s[24:27], s28 offen offset:256 nt
    s_waitcnt vmcnt(17)
    v_cvt_f32_i32 v160, v160
    v_cvt_f32_i32 v161, v161
    v_cvt_f32_i32 v162, v162
    v_cvt_f32_i32 v163, v163
    v_pk_fma_f32 v[76:77], v[160:161], v[98:99], v[76:77] op_sel:[0,0,0] op_sel_hi:[0,1,1]
    v_pk_fma_f32 v[78:79], v[160:161], v[98:99], v[78:79] op_sel:[1,0,0] op_sel_hi:[1,1,1]
    v_pk_fma_f32 v[80:81], v[162:163], v[98:99], v[80:81] op_sel:[0,0,0] op_sel_hi:[0,1,1]
    v_pk_fma_f32 v[82:83], v[162:163], v[98:99], v[82:83] op_sel:[1,0,0] op_sel_hi:[1,1,1]
    buffer_load_dwordx4 v[160:163], v0, s[24:27], s28 offen offset:384 nt
    s_add_u32 s28, s28, s69
    s_add_u32 s40, s40, s69
    s_cmp_eq_u32 s29, 4
    s_cbranch_scc1 L_body8
    s_cmp_eq_u32 s29, 2
    s_cbranch_scc1 L_body4
    s_branch L_body2
    s_nop 4
L_body4:
    s_barrier
    s_waitcnt vmcnt(15)
    v_mov_b32 v12, v168
    v_mov_b32 v13, v169
    s_cmp_lt_u32 s43, s85
    s_cbranch_scc1 L_np4
    s_mov_b64 exec, 1
    v_lshl_add_u32 v19, v19, 2, s67
    ds_write_b32 v5, v19 offset:6208
    s_mov_b64 exec, -1
    s_waitcnt lgkmcnt(0)
    s_nop 4
L_np4:
    v_cvt_f32_i32 v100, v100
    v_cvt_f32_i32 v101, v101
    v_cvt_f32_i32 v102, v102
    v_cvt_f32_i32 v103, v103
    v_pk_mul_f32 v[84:85], v[100:101], v[20:21] op_sel:[0,0] op_sel_hi:[0,1]
    v_pk_fma_f32 v[84:85], v[100:101], v[22:23], v[84:85] op_sel:[1,0,0] op_sel_hi:[1,1,1]
    v_pk_fma_f32 v[84:85], v[102:103], v[24:25], v[84:85] op_sel:[0,0,0] op_sel_hi:[0,1,1]
    v_pk_fma_f32 v[84:85], v[102:103], v[26:27], v[84:85] op_sel:[1,0,0] op_sel_hi:[1,1,1]
    buffer_load_dwordx4 v[100:103], v0, s[12:15], s41 offen offset:0 nt
    s_waitcnt vmcnt(15)
    v_cvt_f32_i32 v104, v104
    v_cvt_f32_i32 v105, v105
    v_cvt_f32_i32 v106, v106
    v_cvt_f32_i32 v107, v107
    v_pk_fma_f32 v[84:85], v[104:105], v[28:29], v[84:85] op_sel:[0,0,0] op_sel_hi:[0,1,1]
    v_pk_fma_f32 v[84:85], v[104:105], v[30:31], v[84:85] op_sel:[1,0,0] op_sel_hi:[1,1,1]
    v_pk_fma_f32 v[84:85], v[106:107], v[32:33], v[84:85] op_sel:[0,0,0] op_sel_hi:[0,1,1]
    v_pk_fma_f32 v[84:85], v[106:107], v[34:35], v[84:85] op_sel:[1,0,0] op_sel_hi:[1,1,1]
    buffer_load_dwordx4 v[104:107], v0, s[12:15], s41 offen offset:128 nt
    s_waitcnt vmcnt(15)
    v_cvt_f32_i32 v108, v108
    v_cvt_f32_i32 v109, v109
    v_cvt_f32_i32 v110, v110
    v_cvt_f32_i32 v111, v111
    v_pk_fma_f32 v[84:85], v[108:109], v[36:37], v[84:85] op_sel:[0,0,0] op_sel_hi:[0,1,1]
    v_pk_fma_f32 v[84:85], v[108:109], v[38:39], v[84:85] op_sel:[1,0,0] op_sel_hi:[1,1,1]
    v_pk_fma_f32 v[84:85], v[110:111], v[40:41], v[84:85] op_sel:[0,0,0] op_sel_hi:[0,1,1]
    v_pk_fma_f32 v[84:85], v[110:111], v[42:43], v[84:85] op_sel:[1,0,0] op_sel_hi:[1,1,1]
    buffer_load_dwordx4 v[108:111], v0, s[12:15], s41 offen offset:256 nt
    s_waitcnt vmcnt(15)
    v_cvt_f32_i32 v112, v112
    v_cvt_f32_i32 v113, v113
    v_cvt_f32_i32 v114, v114
    v_cvt_f32_i32 v115, v115
    v_pk_fma_f32 v[84:85], v[112:113], v[44:45], v[84:85] op_sel:[0,0,0] op_sel_hi:[0,1,1]
    v_pk_fma_f32 v[84:85], v[112:113], v[46:47], v[84:85] op_sel:[1,0,0] op_sel_hi:[1,1,1]
    v_pk_fma_f32 v[84:85], v[114:115], v[48:49], v[84:85] op_sel:[0,0,0] op_sel_hi:[0,1,1]
    v_pk_fma_f32 v[84:85], v[114:115], v[50:51], v[84:85] op_sel:[1,0,0] op_sel_hi:[1,1,1]
    buffer_load_dwordx4 v[112:115], v0, s[12:15], s41 offen offset:384 nt
    s_add_u32 s41, s41, s69
    s_waitcnt vmcnt(15)
    v_cvt_f32_i32 v116, v116
    v_cvt_f32_i32 v117, v117
    v_cvt_f32_i32 v118, v118
    v_cvt_f32_i32 v119, v119
    v_pk_mul_f32 v[86:87], v[116:117], v[20:21] op_sel:[0,0] op_sel_hi:[0,1]
    v_pk_fma_f32 v[86:87], v[116:117], v[22:23], v[86:87] op_sel:[1,0,0] op_sel_hi:[1,1,1]
    v_pk_fma_f32 v[86:87], v[118:119], v[24:25], v[86:87] op_sel:[0,0,0] op_sel_hi:[0,1,1]
    v_pk_fma_f32 v[86:87], v[118:119], v[26:27], v[86:87] op_sel:[1,0,0] op_sel_hi:[1,1,1]
    buffer_load_dwordx4 v[116:119], v0, s[12:15], s41 offen offset:0 nt
    s_waitcnt vmcnt(15)
    v_cvt_f32_i32 v120, v120
    v_cvt_f32_i32 v121, v121
    v_cvt_f32_i32 v122, v122
    v_cvt_f32_i32 v123, v123
    v_pk_fma_f32 v[86:87], v[120:121], v[28:29], v[86:87] op_sel:[0,0,0] op_sel_hi:[0,1,1]
    v_pk_fma_f32 v[86:87], v[120:121], v[30:31], v[86:87] op_sel:[1,0,0] op_sel_hi:[1,1,1]
    v_pk_fma_f32 v[86:87], v[122:123], v[32:33], v[86:87] op_sel:[0,0,0] op_sel_hi:[0,1,1]
    v_pk_fma_f32 v[86:87], v[122:123], v[34:35], v[86:87] op_sel:[1,0,0] op_sel_hi:[1,1,1]
    buffer_load_dwordx4 v[120:123], v0, s[12:15], s41 offen offset:128 nt
    s_waitcnt vmcnt(15)
    v_cvt_f32_i32 v124, v124
    v_cvt_f32_i32 v125, v125
    v_cvt_f32_i32 v126, v126
    v_cvt_f32_i32 v127, v127
    v_pk_fma_f32 v[86:87], v[124:125], v[36:37], v[86:87] op_sel:[0,0,0] op_sel_hi:[0,1,1]
    v_pk_fma_f32 v[86:87], v[124:125], v[38:39], v[86:87] op_sel:[1,0,0] op_sel_hi:[1,1,1]
    v_pk_fma_f32 v[86:87], v[126:127], v[40:41], v[86:87] op_sel:[0,0,0] op_sel_hi:[0,1,1]
    v_pk_fma_f32 v[86:87], v[126:127], v[42:43], v[86:87] op_sel:[1,0,0] op_sel_hi:[1,1,1]
    buffer_load_dwordx4 v[124:127], v0, s[12:15], s41 offen offset:256 nt
    s_waitcnt vmcnt(15)
    v_cvt_f32_i32 v128, v128
    v_cvt_f32_i32 v129, v129
    v_cvt_f32_i32 v130, v130
    v_cvt_f32_i32 v131, v131
    v_pk_fma_f32 v[86:87], v[128:129], v[44:45], v[86:87] op_sel:[0,0,0] op_sel_hi:[0,1,1]
    v_pk_fma_f32 v[86:87], v[128:129], v[46:47], v[86:87] op_sel:[1,0,0] op_sel_hi:[1,1,1]
    v_pk_fma_f32 v[86:87], v[130:131], v[48:49], v[86:87] op_sel:[0,0,0] op_sel_hi:[0,1,1]
    v_pk_fma_f32 v[86:87], v[130:131], v[50:51], v[86:87] op_sel:[1,0,0] op_sel_hi:[1,1,1]
    buffer_load_dwordx4 v[128:131], v0, s[12:15], s41 offen offset:384 nt
    s_add_u32 s41, s41, s69
    v_add_f32_dpp v84, v84, v84 row_half_mirror row_mask:0xf bank_mask:0x5
    v_add_f32_dpp v85, v85, v85 row_half_mirror row_mask:0xf bank_mask:0x5
    s_nop 0
    v_add_f32_dpp v84, v86, v86 row_half_mirror row_mask:0xf bank_mask:0xa
    v_add_f32_dpp v85, v87, v87 row_half_mirror row_mask:0xf bank_mask:0xa
    s_barrier
    ds_read_b32 v164, v5 offset:6208
    s_waitcnt vmcnt(15)
    v_cvt_f32_i32 v132, v132
    v_cvt_f32_i32 v133, v133
    v_cvt_f32_i32 v134, v134
    v_cvt_f32_i32 v135, v135
    v_pk_mul_f32 v[88:89], v[132:133], v[20:21] op_sel:[0,0] op_sel_hi:[0,1]
    v_pk_fma_f32 v[88:89], v[132:133], v[22:23], v[88:89] op_sel:[1,0,0] op_sel_hi:[1,1,1]
    v_pk_fma_f32 v[88:89], v[134:135], v[24:25], v[88:89] op_sel:[0,0,0] op_sel_hi:[0,1,1]
    v_pk_fma_f32 v[88:89], v[134:135], v[26:27], v[88:89] op_sel:[1,0,0] op_sel_hi:[1,1,1]
    buffer_load_dwordx4 v[132:135], v0, s[12:15], s41 offen offset:0 nt
    s_waitcnt vmcnt(15)
    v_cvt_f32_i32 v136, v136
    v_cvt_f32_i32 v137, v137
    v_cvt_f32_i32 v138, v138
    v_cvt_f32_i32 v139, v139
    v_pk_fma_f32 v[88:89], v[136:137], v[28:29], v[88:89] op_sel:[0,0,0] op_sel_hi:[0,1,1]
    v_pk_fma_f32 v[88:89], v[136:137], v[30:31], v[88:89] op_sel:[1,0,0] op_sel_hi:[1,1,1]
    v_pk_fma_f32 v[88:89], v[138:139], v[32:33], v[88:89] op_sel:[0,0,0] op_sel_hi:[0,1,1]
    v_pk_fma_f32 v[88:89], v[138:139], v[34:35], v[88:89] op_sel:[1,0,0] op_sel_hi:[1,1,1]
    buffer_load_dwordx4 v[136:139], v0, s[12:15], s41 offen offset:128 nt
    s_waitcnt vmcnt(15)
    v_cvt_f32_i32 v140, v140
    v_cvt_f32_i32 v141, v141
    v_cvt_f32_i32 v142, v142
    v_cvt_f32_i32 v143, v143
    v_pk_fma_f32 v[88:89], v[140:141], v[36:37], v[88:89] op_sel:[0,0,0] op_sel_hi:[0,1,1]
    v_pk_fma_f32 v[88:89], v[140:141], v[38:39], v[88:89] op_sel:[1,0,0] op_sel_hi:[1,1,1]
    v_pk_fma_f32 v[88:89], v[142:143], v[40:41], v[88:89] op_sel:[0,0,0] op_sel_hi:[0,1,1]
    v_pk_fma_f32 v[88:89], v[142:143], v[42:43], v[88:89] op_sel:[1,0,0] op_sel_hi:[1,1,1]
    buffer_load_dwordx4 v[140:143], v0, s[12:15], s41 offen offset:256 nt
    s_waitcnt vmcnt(15)
    v_cvt_f32_i32 v144, v144
    v_cvt_f32_i32 v145, v145
    v_cvt_f32_i32 v146, v146
    v_cvt_f32_i32 v147, v147
    v_pk_fma_f32 v[88:89], v[144:145], v[44:45], v[88:89] op_sel:[0,0,0] op_sel_hi:[0,1,1]
    v_pk_fma_f32 v[88:89], v[144:145], v[46:47], v[88:89] op_sel:[1,0,0] op_sel_hi:[1,1,1]
    v_pk_fma_f32 v[88:89], v[146:147], v[48:49], v[88:89] op_sel:[0,0,0] op_sel_hi:[0,1,1]
    v_pk_fma_f32 v[88:89], v[146:147], v[50:51], v[88:89] op_sel:[1,0,0] op_sel_hi:[1,1,1]
    buffer_load_dwordx4 v[144:147], v0, s[12:15], s41 offen offset:384 nt
    s_add_u32 s41, s41, s69
    s_waitcnt vmcnt(15)
    v_cvt_f32_i32 v148, v148
    v_cvt_f32_i32 v149, v149
    v_cvt_f32_i32 v150, v150
    v_cvt_f32_i32 v151, v151
    v_pk_mul_f32 v[90:91], v[148:149], v[20:21] op_sel:[0,0] op_sel_hi:[0,1]
    v_pk_fma_f32 v[90:91], v[148:149], v[22:23], v[90:91] op_sel:[1,0,0] op_sel_hi:[1,1,1]
    v_pk_fma_f32 v[90:91], v[150:151], v[24:25], v[90:91] op_sel:[0,0,0] op_sel_hi:[0,1,1]
    v_pk_fma_f32 v[90:91], v[150:151], v[26:27], v[90:91] op_sel:[1,0,0] op_sel_hi:[1,1,1]
    buffer_load_dwordx4 v[148:151], v0, s[12:15], s41 offen offset:0 nt
    s_waitcnt vmcnt(15)
    v_cvt_f32_i32 v152, v152
    v_cvt_f32_i32 v153, v153
    v_cvt_f32_i32 v154, v154
    v_cvt_f32_i32 v155, v155
    v_pk_fma_f32 v[90:91], v[152:153], v[28:29], v[90:91] op_sel:[0,0,0] op_sel_hi:[0,1,1]
    v_pk_fma_f32 v[90:91], v[152:153], v[30:31], v[90:91] op_sel:[1,0,0] op_sel_hi:[1,1,1]
    v_pk_fma_f32 v[90:91], v[154:155], v[32:33], v[90:91] op_sel:[0,0,0] op_sel_hi:[0,1,1]
    v_pk_fma_f32 v[90:91], v[154:155], v[34:35], v[90:91] op_sel:[1,0,0] op_sel_hi:[1,1,1]
    buffer_load_dwordx4 v[152:155], v0, s[12:15], s41 offen offset:128 nt
    s_waitcnt vmcnt(15)
    v_cvt_f32_i32 v156, v156
    v_cvt_f32_i32 v157, v157
    v_cvt_f32_i32 v158, v158
    v_cvt_f32_i32 v159, v159
    v_pk_fma_f32 v[90:91], v[156:157], v[36:37], v[90:91] op_sel:[0,0,0] op_sel_hi:[0,1,1]
    v_pk_fma_f32 v[90:91], v[156:157], v[38:39], v[90:91] op_sel:[1,0,0] op_sel_hi:[1,1,1]
    v_pk_fma_f32 v[90:91], v[158:159], v[40:41], v[90:91] op_sel:[0,0,0] op_sel_hi:[0,1,1]
    v_pk_fma_f32 v[90:91], v[158:159], v[42:43], v[90:91] op_sel:[1,0,0] op_sel_hi:[1,1,1]
    buffer_load_dwordx4 v[156:159], v0, s[12:15], s41 offen offset:256 nt
    s_waitcnt vmcnt(15)
    v_cvt_f32_i32 v160, v160
    v_cvt_f32_i32 v161, v161
    v_cvt_f32_i32 v162, v162
    v_cvt_f32_i32 v163, v163
    v_pk_fma_f32 v[90:91], v[160:161], v[44:45], v[90:91] op_sel:[0,0,0] op_sel_hi:[0,1,1]
    v_pk_fma_f32 v[90:91], v[160:161], v[46:47], v[90:91] op_sel:[1,0,0] op_sel_hi:[1,1,1]
    v_pk_fma_f32 v[90:91], v[162:163], v[48:49], v[90:91] op_sel:[0,0,0] op_sel_hi:[0,1,1]
    v_pk_fma_f32 v[90:91], v[162:163], v[50:51], v[90:91] op_sel:[1,0,0] op_sel_hi:[1,1,1]
    buffer_load_dwordx4 v[160:163], v0, s[12:15], s41 offen offset:384 nt
    s_add_u32 s41, s41, s69
    v_add_f32_dpp v88, v88, v88 row_half_mirror row_mask:0xf bank_mask:0x5
    v_add_f32_dpp v89, v89, v89 row_half_mirror row_mask:0xf bank_mask:0x5
    s_nop 0
    v_add_f32_dpp v88, v90, v90 row_half_mirror row_mask:0xf bank_mask:0xa
    v_add_f32_dpp v89, v91, v91 row_half_mirror row_mask:0xf bank_mask:0xa
    v_cndmask_b32 v6, v88, v84, s[44:45]
    v_cndmask_b32 v88, v84, v88, s[44:45]
    v_cndmask_b32 v7, v89, v85, s[44:45]
    v_cndmask_b32 v89, v85, v89, s[44:45]
    v_add_f32_dpp v84, v6, v88 quad_perm:[2,3,0,1] row_mask:0xf bank_mask:0xf
    s_nop 0
    v_add_f32_dpp v85, v7, v89 quad_perm:[2,3,0,1] row_mask:0xf bank_mask:0xf
    v_add_f32_dpp v84, v84, v84 quad_perm:[1,0,3,2] row_mask:0xf bank_mask:0xf
    s_nop 0
    v_add_f32_dpp v85, v85, v85 quad_perm:[1,0,3,2] row_mask:0xf bank_mask:0xf
    s_barrier
    s_waitcnt lgkmcnt(0)
    v_readfirstlane_b32 s58, v164
    s_nop 3
    s_and_b32 s68, s58, 3
    s_lshr_b32 s58, s58, 2
    s_bfe_u32 s91, s58, 0x10003
    s_add_u32 s91, s91, 2
    s_lshr_b32 s59, s58, 4
    s_lshl_b32 s59, s59, 3
    s_and_b32 s92, s58, 7
    s_add_u32 s59, s59, s92
    s_cmp_ge_u32 s68, 2
    s_cselect_b32 s58, s59, s58
    s_cselect_b32 s68, s91, s68
    s_add_u32 s58, s58, 16
    s_and_b32 s66, s68, 1
    s_lshl_b32 s42, s58, 2
    s_sub_i32 s58, s58, 56
    s_max_i32 s58, s58, 0
    s_min_u32 s58, s58, 62
    s_add_u32 s59, s58, 1
    s_nop 3
    v_readlane_b32 s91, v166, s58
    v_readlane_b32 s92, v166, s59
    s_nop 3
    s_sub_u32 s29, s92, s91
    s_cmp_lt_u32 s42, 224
    s_cselect_b32 s91, s42, s91
    s_cselect_b32 s29, 4, s29
    s_cmp_eq_u32 s29, 0
    s_cbranch_scc1 L_last4
    s_bfe_u32 s58, s91, 0x30002
    s_xor_b32 s92, s66, s31
    s_xor_b32 s92, s92, s58
    s_and_b32 s92, s92, 1
    s_lshl_b32 s92, s92, 4
    s_add_u32 s92, s92, s34
    s_lshl_b32 s59, s66, 8
    s_add_u32 s59, s59, s72
    s_cmp_ge_u32 s68, 2
    s_cselect_b32 s92, s59, s92
    s_cselect_b32 s68, 14, 15
    s_lshl_b32 s69, 1, s68
    s_lshl_b32 s95, s58, 12
    s_add_u32 s95, s95, s92
    s_lshr_b32 s59, s91, 5
    s_lshl_b32 s59, s59, 9
    s_add_u32 s95, s95, s59
    s_lshr_b32 s92, s69, 8
    s_and_b32 s59, s91, 3
    s_mul_i32 s59, s59, s92
    s_add_u32 s95, s95, s59
    s_lshl_b32 s58, s29, 1
    s_sub_u32 s58, s58, 1
    v_and_b32 v167, s58, v1
    v_mad_u32_u24 v167, v167, s92, v165
    s_lshl_b32 s59, s69, 1
    s_lshl_b32 s42, s95, 1
    s_cmp_eq_u32 s29, 1
    s_cselect_b32 s24, s12, s8
    s_cselect_b32 s25, s13, s9
    s_cselect_b32 s30, 0, s59
    buffer_load_ushort v168, v167, s[16:19], s42 offen
    buffer_load_ushort v169, v167, s[20:23], s42 offen
    s_lshl_b32 s40, s95, 9
    s_lshl_b32 s41, s95, 9
    s_add_u32 s28, s40, s30
    s_cmp_eq_u32 s29, 4
    s_cbranch_scc1 L_nt4
    s_cmp_lt_u32 s43, s85
    s_cbranch_scc1 L_nt4
    v_mov_b32 v19, 1
    s_mov_b64 exec, 1
    s_add_u32 s67, s62, s73
    s_mul_i32 s58, s62, 4096
    s_add_u32 s58, s58, s94
    buffer_atomic_add v19, v5, s[36:39], s58 offen sc0
    s_mov_b64 exec, -1
    s_nop 4
L_nt4:
    s_waitcnt lgkmcnt(0)
    v_mov_b32 v6, v84
    v_mov_b32 v7, v85
    v_lshlrev_b32 v12, 16, v12
    v_lshlrev_b32 v13, 16, v13
    v_permlane32_swap_b32 v6, v7
    v_max_f32 v6, v6, v7
    v_mov_b32 v7, v6
    s_nop 1
    v_permlane16_swap_b32 v6, v7
    v_max_f32 v6, v6, v7
    s_nop 1
    v_max_f32_dpp v6, v6, v6 row_ror:8 row_mask:0xf bank_mask:0xf
    s_nop 1
    v_max_f32_dpp v6, v6, v6 row_ror:4 row_mask:0xf bank_mask:0xf
    s_nop 1
    v_max_f32_dpp v6, v6, v6 row_ror:2 row_mask:0xf bank_mask:0xf
    s_nop 1
    v_max_f32_dpp v6, v6, v6 row_ror:1 row_mask:0xf bank_mask:0xf
    v_max_f32 v6, v6, v4
    v_sub_f32 v7, v4, v6
    v_exp_f32 v7, v7
    v_mov_b32 v4, v6
    v_readlane_b32 s48, v6, 0
    v_readlane_b32 s49, v6, 32
    v_readlane_b32 s50, v7, 0
    v_readlane_b32 s51, v7, 32
    v_subrev_f32 v14, s48, v84
    v_subrev_f32 v15, s49, v85
    v_exp_f32 v14, v14
    v_exp_f32 v15, v15
    v_cndmask_b32 v14, v14, 0, s[46:47]
    v_cndmask_b32 v15, v15, 0, s[46:47]
    v_pk_mul_f32 v[10:11], v[10:11], s[50:51]
    v_pk_mul_f32 v[16:17], v[14:15], v[12:13] op_sel:[0,0] op_sel_hi:[1,0]
    v_pk_fma_f32 v[8:9], v[8:9], s[50:51], v[14:15]
    ds_write_b64 v2, v[16:17]
    v_pk_fma_f32 v[10:11], v[16:17], v[12:13], v[10:11] op_sel:[0,1,0] op_sel_hi:[1,1,1]
    ds_read_b128 v[84:87], v3 offset:0
    ds_read_b128 v[88:91], v3 offset:16
    v_pk_mul_f32 v[52:53], v[52:53], s[50:51]
    v_pk_mul_f32 v[54:55], v[54:55], s[50:51]
    v_pk_mul_f32 v[56:57], v[56:57], s[50:51]
    v_pk_mul_f32 v[58:59], v[58:59], s[50:51]
    v_pk_mul_f32 v[60:61], v[60:61], s[50:51]
    v_pk_mul_f32 v[62:63], v[62:63], s[50:51]
    v_pk_mul_f32 v[64:65], v[64:65], s[50:51]
    v_pk_mul_f32 v[66:67], v[66:67], s[50:51]
    v_pk_mul_f32 v[68:69], v[68:69], s[50:51]
    v_pk_mul_f32 v[70:71], v[70:71], s[50:51]
    v_pk_mul_f32 v[72:73], v[72:73], s[50:51]
    v_pk_mul_f32 v[74:75], v[74:75], s[50:51]
    v_pk_mul_f32 v[76:77], v[76:77], s[50:51]
    v_pk_mul_f32 v[78:79], v[78:79], s[50:51]
    v_pk_mul_f32 v[80:81], v[80:81], s[50:51]
    v_pk_mul_f32 v[82:83], v[82:83], s[50:51]
    s_waitcnt lgkmcnt(0)
    s_waitcnt vmcnt(17)
    v_cvt_f32_i32 v100, v100
    v_cvt_f32_i32 v101, v101
    v_cvt_f32_i32 v102, v102
    v_cvt_f32_i32 v103, v103
    v_pk_fma_f32 v[52:53], v[100:101], v[84:85], v[52:53] op_sel:[0,0,0] op_sel_hi:[0,1,1]
    v_pk_fma_f32 v[54:55], v[100:101], v[84:85], v[54:55] op_sel:[1,0,0] op_sel_hi:[1,1,1]
    v_pk_fma_f32 v[56:57], v[102:103], v[84:85], v[56:57] op_sel:[0,0,0] op_sel_hi:[0,1,1]
    v_pk_fma_f32 v[58:59], v[102:103], v[84:85], v[58:59] op_sel:[1,0,0] op_sel_hi:[1,1,1]
    buffer_load_dwordx4 v[100:103], v0, s[8:11], s40 offen offset:0 nt
    s_waitcnt vmcnt(17)
    v_cvt_f32_i32 v104, v104
    v_cvt_f32_i32 v105, v105
    v_cvt_f32_i32 v106, v106
    v_cvt_f32_i32 v107, v107
    v_pk_fma_f32 v[60:61], v[104:105], v[84:85], v[60:61] op_sel:[0,0,0] op_sel_hi:[0,1,1]
    v_pk_fma_f32 v[62:63], v[104:105], v[84:85], v[62:63] op_sel:[1,0,0] op_sel_hi:[1,1,1]
    v_pk_fma_f32 v[64:65], v[106:107], v[84:85], v[64:65] op_sel:[0,0,0] op_sel_hi:[0,1,1]
    v_pk_fma_f32 v[66:67], v[106:107], v[84:85], v[66:67] op_sel:[1,0,0] op_sel_hi:[1,1,1]
    buffer_load_dwordx4 v[104:107], v0, s[8:11], s40 offen offset:128 nt
    s_waitcnt vmcnt(17)
    v_cvt_f32_i32 v108, v108
    v_cvt_f32_i32 v109, v109
    v_cvt_f32_i32 v110, v110
    v_cvt_f32_i32 v111, v111
    v_pk_fma_f32 v[68:69], v[108:109], v[84:85], v[68:69] op_sel:[0,0,0] op_sel_hi:[0,1,1]
    v_pk_fma_f32 v[70:71], v[108:109], v[84:85], v[70:71] op_sel:[1,0,0] op_sel_hi:[1,1,1]
    v_pk_fma_f32 v[72:73], v[110:111], v[84:85], v[72:73] op_sel:[0,0,0] op_sel_hi:[0,1,1]
    v_pk_fma_f32 v[74:75], v[110:111], v[84:85], v[74:75] op_sel:[1,0,0] op_sel_hi:[1,1,1]
    buffer_load_dwordx4 v[108:111], v0, s[8:11], s40 offen offset:256 nt
    s_waitcnt vmcnt(17)
    v_cvt_f32_i32 v112, v112
    v_cvt_f32_i32 v113, v113
    v_cvt_f32_i32 v114, v114
    v_cvt_f32_i32 v115, v115
    v_pk_fma_f32 v[76:77], v[112:113], v[84:85], v[76:77] op_sel:[0,0,0] op_sel_hi:[0,1,1]
    v_pk_fma_f32 v[78:79], v[112:113], v[84:85], v[78:79] op_sel:[1,0,0] op_sel_hi:[1,1,1]
    v_pk_fma_f32 v[80:81], v[114:115], v[84:85], v[80:81] op_sel:[0,0,0] op_sel_hi:[0,1,1]
    v_pk_fma_f32 v[82:83], v[114:115], v[84:85], v[82:83] op_sel:[1,0,0] op_sel_hi:[1,1,1]
    buffer_load_dwordx4 v[112:115], v0, s[8:11], s40 offen offset:384 nt
    s_add_u32 s40, s40, s69
    s_waitcnt vmcnt(17)
    v_cvt_f32_i32 v116, v116
    v_cvt_f32_i32 v117, v117
    v_cvt_f32_i32 v118, v118
    v_cvt_f32_i32 v119, v119
    v_pk_fma_f32 v[52:53], v[116:117], v[86:87], v[52:53] op_sel:[0,0,0] op_sel_hi:[0,1,1]
    v_pk_fma_f32 v[54:55], v[116:117], v[86:87], v[54:55] op_sel:[1,0,0] op_sel_hi:[1,1,1]
    v_pk_fma_f32 v[56:57], v[118:119], v[86:87], v[56:57] op_sel:[0,0,0] op_sel_hi:[0,1,1]
    v_pk_fma_f32 v[58:59], v[118:119], v[86:87], v[58:59] op_sel:[1,0,0] op_sel_hi:[1,1,1]
    buffer_load_dwordx4 v[116:119], v0, s[8:11], s40 offen offset:0 nt
    s_waitcnt vmcnt(17)
    v_cvt_f32_i32 v120, v120
    v_cvt_f32_i32 v121, v121
    v_cvt_f32_i32 v122, v122
    v_cvt_f32_i32 v123, v123
    v_pk_fma_f32 v[60:61], v[120:121], v[86:87], v[60:61] op_sel:[0,0,0] op_sel_hi:[0,1,1]
    v_pk_fma_f32 v[62:63], v[120:121], v[86:87], v[62:63] op_sel:[1,0,0] op_sel_hi:[1,1,1]
    v_pk_fma_f32 v[64:65], v[122:123], v[86:87], v[64:65] op_sel:[0,0,0] op_sel_hi:[0,1,1]
    v_pk_fma_f32 v[66:67], v[122:123], v[86:87], v[66:67] op_sel:[1,0,0] op_sel_hi:[1,1,1]
    buffer_load_dwordx4 v[120:123], v0, s[8:11], s40 offen offset:128 nt
    s_waitcnt vmcnt(17)
    v_cvt_f32_i32 v124, v124
    v_cvt_f32_i32 v125, v125
    v_cvt_f32_i32 v126, v126
    v_cvt_f32_i32 v127, v127
    v_pk_fma_f32 v[68:69], v[124:125], v[86:87], v[68:69] op_sel:[0,0,0] op_sel_hi:[0,1,1]
    v_pk_fma_f32 v[70:71], v[124:125], v[86:87], v[70:71] op_sel:[1,0,0] op_sel_hi:[1,1,1]
    v_pk_fma_f32 v[72:73], v[126:127], v[86:87], v[72:73] op_sel:[0,0,0] op_sel_hi:[0,1,1]
    v_pk_fma_f32 v[74:75], v[126:127], v[86:87], v[74:75] op_sel:[1,0,0] op_sel_hi:[1,1,1]
    buffer_load_dwordx4 v[124:127], v0, s[8:11], s40 offen offset:256 nt
    s_waitcnt vmcnt(17)
    v_cvt_f32_i32 v128, v128
    v_cvt_f32_i32 v129, v129
    v_cvt_f32_i32 v130, v130
    v_cvt_f32_i32 v131, v131
    v_pk_fma_f32 v[76:77], v[128:129], v[86:87], v[76:77] op_sel:[0,0,0] op_sel_hi:[0,1,1]
    v_pk_fma_f32 v[78:79], v[128:129], v[86:87], v[78:79] op_sel:[1,0,0] op_sel_hi:[1,1,1]
    v_pk_fma_f32 v[80:81], v[130:131], v[86:87], v[80:81] op_sel:[0,0,0] op_sel_hi:[0,1,1]
    v_pk_fma_f32 v[82:83], v[130:131], v[86:87], v[82:83] op_sel:[1,0,0] op_sel_hi:[1,1,1]
    buffer_load_dwordx4 v[128:131], v0, s[8:11], s40 offen offset:384 nt
    s_add_u32 s40, s40, s69
    s_barrier
    s_waitcnt vmcnt(17)
    v_cvt_f32_i32 v132, v132
    v_cvt_f32_i32 v133, v133
    v_cvt_f32_i32 v134, v134
    v_cvt_f32_i32 v135, v135
    v_pk_fma_f32 v[52:53], v[132:133], v[88:89], v[52:53] op_sel:[0,0,0] op_sel_hi:[0,1,1]
    v_pk_fma_f32 v[54:55], v[132:133], v[88:89], v[54:55] op_sel:[1,0,0] op_sel_hi:[1,1,1]
    v_pk_fma_f32 v[56:57], v[134:135], v[88:89], v[56:57] op_sel:[0,0,0] op_sel_hi:[0,1,1]
    v_pk_fma_f32 v[58:59], v[134:135], v[88:89], v[58:59] op_sel:[1,0,0] op_sel_hi:[1,1,1]
    buffer_load_dwordx4 v[132:135], v0, s[24:27], s28 offen offset:0 nt
    s_waitcnt vmcnt(17)
    v_cvt_f32_i32 v136, v136
    v_cvt_f32_i32 v137, v137
    v_cvt_f32_i32 v138, v138
    v_cvt_f32_i32 v139, v139
    v_pk_fma_f32 v[60:61], v[136:137], v[88:89], v[60:61] op_sel:[0,0,0] op_sel_hi:[0,1,1]
    v_pk_fma_f32 v[62:63], v[136:137], v[88:89], v[62:63] op_sel:[1,0,0] op_sel_hi:[1,1,1]
    v_pk_fma_f32 v[64:65], v[138:139], v[88:89], v[64:65] op_sel:[0,0,0] op_sel_hi:[0,1,1]
    v_pk_fma_f32 v[66:67], v[138:139], v[88:89], v[66:67] op_sel:[1,0,0] op_sel_hi:[1,1,1]
    buffer_load_dwordx4 v[136:139], v0, s[24:27], s28 offen offset:128 nt
    s_waitcnt vmcnt(17)
    v_cvt_f32_i32 v140, v140
    v_cvt_f32_i32 v141, v141
    v_cvt_f32_i32 v142, v142
    v_cvt_f32_i32 v143, v143
    v_pk_fma_f32 v[68:69], v[140:141], v[88:89], v[68:69] op_sel:[0,0,0] op_sel_hi:[0,1,1]
    v_pk_fma_f32 v[70:71], v[140:141], v[88:89], v[70:71] op_sel:[1,0,0] op_sel_hi:[1,1,1]
    v_pk_fma_f32 v[72:73], v[142:143], v[88:89], v[72:73] op_sel:[0,0,0] op_sel_hi:[0,1,1]
    v_pk_fma_f32 v[74:75], v[142:143], v[88:89], v[74:75] op_sel:[1,0,0] op_sel_hi:[1,1,1]
    buffer_load_dwordx4 v[140:143], v0, s[24:27], s28 offen offset:256 nt
    s_waitcnt vmcnt(17)
    v_cvt_f32_i32 v144, v144
    v_cvt_f32_i32 v145, v145
    v_cvt_f32_i32 v146, v146
    v_cvt_f32_i32 v147, v147
    v_pk_fma_f32 v[76:77], v[144:145], v[88:89], v[76:77] op_sel:[0,0,0] op_sel_hi:[0,1,1]
    v_pk_fma_f32 v[78:79], v[144:145], v[88:89], v[78:79] op_sel:[1,0,0] op_sel_hi:[1,1,1]
    v_pk_fma_f32 v[80:81], v[146:147], v[88:89], v[80:81] op_sel:[0,0,0] op_sel_hi:[0,1,1]
    v_pk_fma_f32 v[82:83], v[146:147], v[88:89], v[82:83] op_sel:[1,0,0] op_sel_hi:[1,1,1]
    buffer_load_dwordx4 v[144:147], v0, s[24:27], s28 offen offset:384 nt
    s_add_u32 s28, s28, s69
    s_add_u32 s40, s40, s69
    s_waitcnt vmcnt(17)
    v_cvt_f32_i32 v148, v148
    v_cvt_f32_i32 v149, v149
    v_cvt_f32_i32 v150, v150
    v_cvt_f32_i32 v151, v151
    v_pk_fma_f32 v[52:53], v[148:149], v[90:91], v[52:53] op_sel:[0,0,0] op_sel_hi:[0,1,1]
    v_pk_fma_f32 v[54:55], v[148:149], v[90:91], v[54:55] op_sel:[1,0,0] op_sel_hi:[1,1,1]
    v_pk_fma_f32 v[56:57], v[150:151], v[90:91], v[56:57] op_sel:[0,0,0] op_sel_hi:[0,1,1]
    v_pk_fma_f32 v[58:59], v[150:151], v[90:91], v[58:59] op_sel:[1,0,0] op_sel_hi:[1,1,1]
    buffer_load_dwordx4 v[148:151], v0, s[24:27], s28 offen offset:0 nt
    s_waitcnt vmcnt(17)
    v_cvt_f32_i32 v152, v152
    v_cvt_f32_i32 v153, v153
    v_cvt_f32_i32 v154, v154
    v_cvt_f32_i32 v155, v155
    v_pk_fma_f32 v[60:61], v[152:153], v[90:91], v[60:61] op_sel:[0,0,0] op_sel_hi:[0,1,1]
    v_pk_fma_f32 v[62:63], v[152:153], v[90:91], v[62:63] op_sel:[1,0,0] op_sel_hi:[1,1,1]
    v_pk_fma_f32 v[64:65], v[154:155], v[90:91], v[64:65] op_sel:[0,0,0] op_sel_hi:[0,1,1]
    v_pk_fma_f32 v[66:67], v[154:155], v[90:91], v[66:67] op_sel:[1,0,0] op_sel_hi:[1,1,1]
    buffer_load_dwordx4 v[152:155], v0, s[24:27], s28 offen offset:128 nt
    s_waitcnt vmcnt(17)
    v_cvt_f32_i32 v156, v156
    v_cvt_f32_i32 v157, v157
    v_cvt_f32_i32 v158, v158
    v_cvt_f32_i32 v159, v159
    v_pk_fma_f32 v[68:69], v[156:157], v[90:91], v[68:69] op_sel:[0,0,0] op_sel_hi:[0,1,1]
    v_pk_fma_f32 v[70:71], v[156:157], v[90:91], v[70:71] op_sel:[1,0,0] op_sel_hi:[1,1,1]
    v_pk_fma_f32 v[72:73], v[158:159], v[90:91], v[72:73] op_sel:[0,0,0] op_sel_hi:[0,1,1]
    v_pk_fma_f32 v[74:75], v[158:159], v[90:91], v[74:75] op_sel:[1,0,0] op_sel_hi:[1,1,1]
    buffer_load_dwordx4 v[156:159], v0, s[24:27], s28 offen offset:256 nt
    s_waitcnt vmcnt(17)
    v_cvt_f32_i32 v160, v160
    v_cvt_f32_i32 v161, v161
    v_cvt_f32_i32 v162, v162
    v_cvt_f32_i32 v163, v163
    v_pk_fma_f32 v[76:77], v[160:161], v[90:91], v[76:77] op_sel:[0,0,0] op_sel_hi:[0,1,1]
    v_pk_fma_f32 v[78:79], v[160:161], v[90:91], v[78:79] op_sel:[1,0,0] op_sel_hi:[1,1,1]
    v_pk_fma_f32 v[80:81], v[162:163], v[90:91], v[80:81] op_sel:[0,0,0] op_sel_hi:[0,1,1]
    v_pk_fma_f32 v[82:83], v[162:163], v[90:91], v[82:83] op_sel:[1,0,0] op_sel_hi:[1,1,1]
    buffer_load_dwordx4 v[160:163], v0, s[24:27], s28 offen offset:384 nt
    s_add_u32 s28, s28, s69
    s_add_u32 s40, s40, s69
    s_cmp_eq_u32 s29, 2
    s_cbranch_scc1 L_body4
    s_cmp_eq_u32 s29, 4
    s_cbranch_scc1 L_body8
    s_branch L_body2
    s_nop 4
L_body2:
    s_waitcnt vmcnt(15)
    v_mov_b32 v12, v168
    v_mov_b32 v13, v169
    s_cmp_lt_u32 s43, s85
    s_cbranch_scc1 L_np2
    s_mov_b64 exec, 1
    v_lshl_add_u32 v19, v19, 2, s67
    ds_write_b32 v5, v19 offset:6208
    s_mov_b64 exec, -1
    s_waitcnt lgkmcnt(0)
    s_nop 4
L_np2:
    s_barrier
    ds_read_b32 v164, v5 offset:6208
    v_cvt_f32_i32 v100, v100
    v_cvt_f32_i32 v101, v101
    v_cvt_f32_i32 v102, v102
    v_cvt_f32_i32 v103, v103
    v_pk_mul_f32 v[84:85], v[100:101], v[20:21] op_sel:[0,0] op_sel_hi:[0,1]
    v_pk_fma_f32 v[84:85], v[100:101], v[22:23], v[84:85] op_sel:[1,0,0] op_sel_hi:[1,1,1]
    v_pk_fma_f32 v[84:85], v[102:103], v[24:25], v[84:85] op_sel:[0,0,0] op_sel_hi:[0,1,1]
    v_pk_fma_f32 v[84:85], v[102:103], v[26:27], v[84:85] op_sel:[1,0,0] op_sel_hi:[1,1,1]
    s_waitcnt lgkmcnt(0)
    v_readfirstlane_b32 s58, v164
    s_nop 3
    s_and_b32 s68, s58, 3
    s_lshr_b32 s58, s58, 2
    s_bfe_u32 s91, s58, 0x10003
    s_add_u32 s91, s91, 2
    s_lshr_b32 s59, s58, 4
    s_lshl_b32 s59, s59, 3
    s_and_b32 s92, s58, 7
    s_add_u32 s59, s59, s92
    s_cmp_ge_u32 s68, 2
    s_cselect_b32 s58, s59, s58
    s_cselect_b32 s68, s91, s68
    s_add_u32 s58, s58, 16
    s_and_b32 s66, s68, 1
    s_lshl_b32 s42, s58, 2
    s_sub_i32 s58, s58, 56
    s_max_i32 s58, s58, 0
    s_min_u32 s58, s58, 62
    s_add_u32 s59, s58, 1
    s_nop 3
    v_readlane_b32 s91, v166, s58
    v_readlane_b32 s92, v166, s59
    s_nop 3
    s_sub_u32 s29, s92, s91
    s_cmp_lt_u32 s42, 224
    s_cselect_b32 s91, s42, s91
    s_cselect_b32 s29, 4, s29
    s_cmp_eq_u32 s29, 0
    s_cbranch_scc1 L_last2
    s_bfe_u32 s58, s91, 0x30002
    s_xor_b32 s92, s66, s31
    s_xor_b32 s92, s92, s58
    s_and_b32 s92, s92, 1
    s_lshl_b32 s92, s92, 4
    s_add_u32 s92, s92, s34
    s_lshl_b32 s59, s66, 8
    s_add_u32 s59, s59, s72
    s_cmp_ge_u32 s68, 2
    s_cselect_b32 s92, s59, s92
    s_cselect_b32 s68, 14, 15
    s_lshl_b32 s69, 1, s68
    s_lshl_b32 s95, s58, 12
    s_add_u32 s95, s95, s92
    s_lshr_b32 s59, s91, 5
    s_lshl_b32 s59, s59, 9
    s_add_u32 s95, s95, s59
    s_lshr_b32 s92, s69, 8
    s_and_b32 s59, s91, 3
    s_mul_i32 s59, s59, s92
    s_add_u32 s95, s95, s59
    s_lshl_b32 s58, s29, 1
    s_sub_u32 s58, s58, 1
    v_and_b32 v167, s58, v1
    v_mad_u32_u24 v167, v167, s92, v165
    s_lshl_b32 s59, s69, 1
    s_lshl_b32 s42, s95, 1
    s_cmp_eq_u32 s29, 1
    s_cselect_b32 s24, s12, s8
    s_cselect_b32 s25, s13, s9
    s_cselect_b32 s30, 0, s59
    buffer_load_ushort v168, v167, s[16:19], s42 offen
    buffer_load_ushort v169, v167, s[20:23], s42 offen
    s_lshl_b32 s40, s95, 9
    s_lshl_b32 s41, s95, 9
    s_add_u32 s28, s40, s30
    s_cmp_eq_u32 s29, 4
    s_cbranch_scc1 L_nt2
    s_cmp_lt_u32 s43, s85
    s_cbranch_scc1 L_nt2
    v_mov_b32 v19, 1
    s_mov_b64 exec, 1
    s_add_u32 s67, s62, s73
    s_mul_i32 s58, s62, 4096
    s_add_u32 s58, s58, s94
    buffer_atomic_add v19, v5, s[36:39], s58 offen sc0
    s_mov_b64 exec, -1
    s_nop 4
L_nt2:
    buffer_load_dwordx4 v[100:103], v0, s[8:11], s40 offen offset:0 nt
    s_waitcnt vmcnt(17)
    v_cvt_f32_i32 v104, v104
    v_cvt_f32_i32 v105, v105
    v_cvt_f32_i32 v106, v106
    v_cvt_f32_i32 v107, v107
    v_pk_fma_f32 v[84:85], v[104:105], v[28:29], v[84:85] op_sel:[0,0,0] op_sel_hi:[0,1,1]
    v_pk_fma_f32 v[84:85], v[104:105], v[30:31], v[84:85] op_sel:[1,0,0] op_sel_hi:[1,1,1]
    v_pk_fma_f32 v[84:85], v[106:107], v[32:33], v[84:85] op_sel:[0,0,0] op_sel_hi:[0,1,1]
    v_pk_fma_f32 v[84:85], v[106:107], v[34:35], v[84:85] op_sel:[1,0,0] op_sel_hi:[1,1,1]
    buffer_load_dwordx4 v[104:107], v0, s[8:11], s40 offen offset:128 nt
    s_waitcnt vmcnt(17)
    v_cvt_f32_i32 v108, v108
    v_cvt_f32_i32 v109, v109
    v_cvt_f32_i32 v110, v110
    v_cvt_f32_i32 v111, v111
    v_pk_fma_f32 v[84:85], v[108:109], v[36:37], v[84:85] op_sel:[0,0,0] op_sel_hi:[0,1,1]
    v_pk_fma_f32 v[84:85], v[108:109], v[38:39], v[84:85] op_sel:[1,0,0] op_sel_hi:[1,1,1]
    v_pk_fma_f32 v[84:85], v[110:111], v[40:41], v[84:85] op_sel:[0,0,0] op_sel_hi:[0,1,1]
    v_pk_fma_f32 v[84:85], v[110:111], v[42:43], v[84:85] op_sel:[1,0,0] op_sel_hi:[1,1,1]
    buffer_load_dwordx4 v[108:111], v0, s[8:11], s40 offen offset:256 nt
    s_waitcnt vmcnt(17)
    v_cvt_f32_i32 v112, v112
    v_cvt_f32_i32 v113, v113
    v_cvt_f32_i32 v114, v114
    v_cvt_f32_i32 v115, v115
    v_pk_fma_f32 v[84:85], v[112:113], v[44:45], v[84:85] op_sel:[0,0,0] op_sel_hi:[0,1,1]
    v_pk_fma_f32 v[84:85], v[112:113], v[46:47], v[84:85] op_sel:[1,0,0] op_sel_hi:[1,1,1]
    v_pk_fma_f32 v[84:85], v[114:115], v[48:49], v[84:85] op_sel:[0,0,0] op_sel_hi:[0,1,1]
    v_pk_fma_f32 v[84:85], v[114:115], v[50:51], v[84:85] op_sel:[1,0,0] op_sel_hi:[1,1,1]
    buffer_load_dwordx4 v[112:115], v0, s[8:11], s40 offen offset:384 nt
    s_add_u32 s40, s40, s69
    s_waitcnt vmcnt(17)
    v_cvt_f32_i32 v116, v116
    v_cvt_f32_i32 v117, v117
    v_cvt_f32_i32 v118, v118
    v_cvt_f32_i32 v119, v119
    v_pk_mul_f32 v[86:87], v[116:117], v[20:21] op_sel:[0,0] op_sel_hi:[0,1]
    v_pk_fma_f32 v[86:87], v[116:117], v[22:23], v[86:87] op_sel:[1,0,0] op_sel_hi:[1,1,1]
    v_pk_fma_f32 v[86:87], v[118:119], v[24:25], v[86:87] op_sel:[0,0,0] op_sel_hi:[0,1,1]
    v_pk_fma_f32 v[86:87], v[118:119], v[26:27], v[86:87] op_sel:[1,0,0] op_sel_hi:[1,1,1]
    buffer_load_dwordx4 v[116:119], v0, s[8:11], s40 offen offset:0 nt
    s_waitcnt vmcnt(17)
    v_cvt_f32_i32 v120, v120
    v_cvt_f32_i32 v121, v121
    v_cvt_f32_i32 v122, v122
    v_cvt_f32_i32 v123, v123
    v_pk_fma_f32 v[86:87], v[120:121], v[28:29], v[86:87] op_sel:[0,0,0] op_sel_hi:[0,1,1]
    v_pk_fma_f32 v[86:87], v[120:121], v[30:31], v[86:87] op_sel:[1,0,0] op_sel_hi:[1,1,1]
    v_pk_fma_f32 v[86:87], v[122:123], v[32:33], v[86:87] op_sel:[0,0,0] op_sel_hi:[0,1,1]
    v_pk_fma_f32 v[86:87], v[122:123], v[34:35], v[86:87] op_sel:[1,0,0] op_sel_hi:[1,1,1]
    buffer_load_dwordx4 v[120:123], v0, s[8:11], s40 offen offset:128 nt
    s_waitcnt vmcnt(17)
    v_cvt_f32_i32 v124, v124
    v_cvt_f32_i32 v125, v125
    v_cvt_f32_i32 v126, v126
    v_cvt_f32_i32 v127, v127
    v_pk_fma_f32 v[86:87], v[124:125], v[36:37], v[86:87] op_sel:[0,0,0] op_sel_hi:[0,1,1]
    v_pk_fma_f32 v[86:87], v[124:125], v[38:39], v[86:87] op_sel:[1,0,0] op_sel_hi:[1,1,1]
    v_pk_fma_f32 v[86:87], v[126:127], v[40:41], v[86:87] op_sel:[0,0,0] op_sel_hi:[0,1,1]
    v_pk_fma_f32 v[86:87], v[126:127], v[42:43], v[86:87] op_sel:[1,0,0] op_sel_hi:[1,1,1]
    buffer_load_dwordx4 v[124:127], v0, s[8:11], s40 offen offset:256 nt
    s_waitcnt vmcnt(17)
    v_cvt_f32_i32 v128, v128
    v_cvt_f32_i32 v129, v129
    v_cvt_f32_i32 v130, v130
    v_cvt_f32_i32 v131, v131
    v_pk_fma_f32 v[86:87], v[128:129], v[44:45], v[86:87] op_sel:[0,0,0] op_sel_hi:[0,1,1]
    v_pk_fma_f32 v[86:87], v[128:129], v[46:47], v[86:87] op_sel:[1,0,0] op_sel_hi:[1,1,1]
    v_pk_fma_f32 v[86:87], v[130:131], v[48:49], v[86:87] op_sel:[0,0,0] op_sel_hi:[0,1,1]
    v_pk_fma_f32 v[86:87], v[130:131], v[50:51], v[86:87] op_sel:[1,0,0] op_sel_hi:[1,1,1]
    buffer_load_dwordx4 v[128:131], v0, s[8:11], s40 offen offset:384 nt
    s_add_u32 s40, s40, s69
    v_add_f32_dpp v84, v84, v84 row_half_mirror row_mask:0xf bank_mask:0x5
    v_add_f32_dpp v85, v85, v85 row_half_mirror row_mask:0xf bank_mask:0x5
    s_nop 0
    v_add_f32_dpp v84, v86, v86 row_half_mirror row_mask:0xf bank_mask:0xa
    v_add_f32_dpp v85, v87, v87 row_half_mirror row_mask:0xf bank_mask:0xa
    s_nop 0
    v_add_f32_dpp v84, v84, v84 quad_perm:[2,3,0,1] row_mask:0xf bank_mask:0xf
    v_add_f32_dpp v85, v85, v85 quad_perm:[2,3,0,1] row_mask:0xf bank_mask:0xf
    s_nop 0
    v_add_f32_dpp v84, v84, v84 quad_perm:[1,0,3,2] row_mask:0xf bank_mask:0xf
    v_add_f32_dpp v85, v85, v85 quad_perm:[1,0,3,2] row_mask:0xf bank_mask:0xf
    s_barrier
    s_waitcnt lgkmcnt(0)
    v_mov_b32 v6, v84
    v_mov_b32 v7, v85
    v_lshlrev_b32 v12, 16, v12
    v_lshlrev_b32 v13, 16, v13
    v_permlane32_swap_b32 v6, v7
    v_max_f32 v6, v6, v7
    v_mov_b32 v7, v6
    s_nop 1
    v_permlane16_swap_b32 v6, v7
    v_max_f32 v6, v6, v7
    s_nop 1
    v_max_f32_dpp v6, v6, v6 row_ror:8 row_mask:0xf bank_mask:0xf
    s_nop 1
    v_max_f32_dpp v6, v6, v6 row_ror:4 row_mask:0xf bank_mask:0xf
    s_nop 1
    v_max_f32_dpp v6, v6, v6 row_ror:2 row_mask:0xf bank_mask:0xf
    s_nop 1
    v_max_f32_dpp v6, v6, v6 row_ror:1 row_mask:0xf bank_mask:0xf
    v_max_f32 v6, v6, v4
    v_sub_f32 v7, v4, v6
    v_exp_f32 v7, v7
    v_mov_b32 v4, v6
    v_readlane_b32 s48, v6, 0
    v_readlane_b32 s49, v6, 32
    v_readlane_b32 s50, v7, 0
    v_readlane_b32 s51, v7, 32
    v_subrev_f32 v14, s48, v84
    v_subrev_f32 v15, s49, v85
    v_exp_f32 v14, v14
    v_exp_f32 v15, v15
    v_cndmask_b32 v14, v14, 0, s[32:33]
    v_cndmask_b32 v15, v15, 0, s[32:33]
    v_pk_mul_f32 v[10:11], v[10:11], s[50:51]
    v_pk_mul_f32 v[16:17], v[14:15], v[12:13] op_sel:[0,0] op_sel_hi:[1,0]
    v_pk_fma_f32 v[8:9], v[8:9], s[50:51], v[14:15]
    ds_write_b64 v2, v[16:17]
    v_pk_fma_f32 v[10:11], v[16:17], v[12:13], v[10:11] op_sel:[0,1,0] op_sel_hi:[1,1,1]
    ds_read_b128 v[84:87], v3 offset:0
    v_pk_mul_f32 v[52:53], v[52:53], s[50:51]
    v_pk_mul_f32 v[54:55], v[54:55], s[50:51]
    v_pk_mul_f32 v[56:57], v[56:57], s[50:51]
    v_pk_mul_f32 v[58:59], v[58:59], s[50:51]
    v_pk_mul_f32 v[60:61], v[60:61], s[50:51]
    v_pk_mul_f32 v[62:63], v[62:63], s[50:51]
    v_pk_mul_f32 v[64:65], v[64:65], s[50:51]
    v_pk_mul_f32 v[66:67], v[66:67], s[50:51]
    v_pk_mul_f32 v[68:69], v[68:69], s[50:51]
    v_pk_mul_f32 v[70:71], v[70:71], s[50:51]
    v_pk_mul_f32 v[72:73], v[72:73], s[50:51]
    v_pk_mul_f32 v[74:75], v[74:75], s[50:51]
    v_pk_mul_f32 v[76:77], v[76:77], s[50:51]
    v_pk_mul_f32 v[78:79], v[78:79], s[50:51]
    v_pk_mul_f32 v[80:81], v[80:81], s[50:51]
    v_pk_mul_f32 v[82:83], v[82:83], s[50:51]
    s_waitcnt lgkmcnt(0)
    s_waitcnt vmcnt(17)
    v_cvt_f32_i32 v132, v132
    v_cvt_f32_i32 v133, v133
    v_cvt_f32_i32 v134, v134
    v_cvt_f32_i32 v135, v135
    v_pk_fma_f32 v[52:53], v[132:133], v[84:85], v[52:53] op_sel:[0,0,0] op_sel_hi:[0,1,1]
    v_pk_fma_f32 v[54:55], v[132:133], v[84:85], v[54:55] op_sel:[1,0,0] op_sel_hi:[1,1,1]
    v_pk_fma_f32 v[56:57], v[134:135], v[84:85], v[56:57] op_sel:[0,0,0] op_sel_hi:[0,1,1]
    v_pk_fma_f32 v[58:59], v[134:135], v[84:85], v[58:59] op_sel:[1,0,0] op_sel_hi:[1,1,1]
    buffer_load_dwordx4 v[132:135], v0, s[24:27], s28 offen offset:0 nt
    s_waitcnt vmcnt(17)
    v_cvt_f32_i32 v136, v136
    v_cvt_f32_i32 v137, v137
    v_cvt_f32_i32 v138, v138
    v_cvt_f32_i32 v139, v139
    v_pk_fma_f32 v[60:61], v[136:137], v[84:85], v[60:61] op_sel:[0,0,0] op_sel_hi:[0,1,1]
    v_pk_fma_f32 v[62:63], v[136:137], v[84:85], v[62:63] op_sel:[1,0,0] op_sel_hi:[1,1,1]
    v_pk_fma_f32 v[64:65], v[138:139], v[84:85], v[64:65] op_sel:[0,0,0] op_sel_hi:[0,1,1]
    v_pk_fma_f32 v[66:67], v[138:139], v[84:85], v[66:67] op_sel:[1,0,0] op_sel_hi:[1,1,1]
    buffer_load_dwordx4 v[136:139], v0, s[24:27], s28 offen offset:128 nt
    s_waitcnt vmcnt(17)
    v_cvt_f32_i32 v140, v140
    v_cvt_f32_i32 v141, v141
    v_cvt_f32_i32 v142, v142
    v_cvt_f32_i32 v143, v143
    v_pk_fma_f32 v[68:69], v[140:141], v[84:85], v[68:69] op_sel:[0,0,0] op_sel_hi:[0,1,1]
    v_pk_fma_f32 v[70:71], v[140:141], v[84:85], v[70:71] op_sel:[1,0,0] op_sel_hi:[1,1,1]
    v_pk_fma_f32 v[72:73], v[142:143], v[84:85], v[72:73] op_sel:[0,0,0] op_sel_hi:[0,1,1]
    v_pk_fma_f32 v[74:75], v[142:143], v[84:85], v[74:75] op_sel:[1,0,0] op_sel_hi:[1,1,1]
    buffer_load_dwordx4 v[140:143], v0, s[24:27], s28 offen offset:256 nt
    s_waitcnt vmcnt(17)
    v_cvt_f32_i32 v144, v144
    v_cvt_f32_i32 v145, v145
    v_cvt_f32_i32 v146, v146
    v_cvt_f32_i32 v147, v147
    v_pk_fma_f32 v[76:77], v[144:145], v[84:85], v[76:77] op_sel:[0,0,0] op_sel_hi:[0,1,1]
    v_pk_fma_f32 v[78:79], v[144:145], v[84:85], v[78:79] op_sel:[1,0,0] op_sel_hi:[1,1,1]
    v_pk_fma_f32 v[80:81], v[146:147], v[84:85], v[80:81] op_sel:[0,0,0] op_sel_hi:[0,1,1]
    v_pk_fma_f32 v[82:83], v[146:147], v[84:85], v[82:83] op_sel:[1,0,0] op_sel_hi:[1,1,1]
    buffer_load_dwordx4 v[144:147], v0, s[24:27], s28 offen offset:384 nt
    s_add_u32 s28, s28, s69
    s_add_u32 s40, s40, s69
    s_waitcnt vmcnt(17)
    v_cvt_f32_i32 v148, v148
    v_cvt_f32_i32 v149, v149
    v_cvt_f32_i32 v150, v150
    v_cvt_f32_i32 v151, v151
    v_pk_fma_f32 v[52:53], v[148:149], v[86:87], v[52:53] op_sel:[0,0,0] op_sel_hi:[0,1,1]
    v_pk_fma_f32 v[54:55], v[148:149], v[86:87], v[54:55] op_sel:[1,0,0] op_sel_hi:[1,1,1]
    v_pk_fma_f32 v[56:57], v[150:151], v[86:87], v[56:57] op_sel:[0,0,0] op_sel_hi:[0,1,1]
    v_pk_fma_f32 v[58:59], v[150:151], v[86:87], v[58:59] op_sel:[1,0,0] op_sel_hi:[1,1,1]
    buffer_load_dwordx4 v[148:151], v0, s[24:27], s28 offen offset:0 nt
    s_waitcnt vmcnt(17)
    v_cvt_f32_i32 v152, v152
    v_cvt_f32_i32 v153, v153
    v_cvt_f32_i32 v154, v154
    v_cvt_f32_i32 v155, v155
    v_pk_fma_f32 v[60:61], v[152:153], v[86:87], v[60:61] op_sel:[0,0,0] op_sel_hi:[0,1,1]
    v_pk_fma_f32 v[62:63], v[152:153], v[86:87], v[62:63] op_sel:[1,0,0] op_sel_hi:[1,1,1]
    v_pk_fma_f32 v[64:65], v[154:155], v[86:87], v[64:65] op_sel:[0,0,0] op_sel_hi:[0,1,1]
    v_pk_fma_f32 v[66:67], v[154:155], v[86:87], v[66:67] op_sel:[1,0,0] op_sel_hi:[1,1,1]
    buffer_load_dwordx4 v[152:155], v0, s[24:27], s28 offen offset:128 nt
    s_waitcnt vmcnt(17)
    v_cvt_f32_i32 v156, v156
    v_cvt_f32_i32 v157, v157
    v_cvt_f32_i32 v158, v158
    v_cvt_f32_i32 v159, v159
    v_pk_fma_f32 v[68:69], v[156:157], v[86:87], v[68:69] op_sel:[0,0,0] op_sel_hi:[0,1,1]
    v_pk_fma_f32 v[70:71], v[156:157], v[86:87], v[70:71] op_sel:[1,0,0] op_sel_hi:[1,1,1]
    v_pk_fma_f32 v[72:73], v[158:159], v[86:87], v[72:73] op_sel:[0,0,0] op_sel_hi:[0,1,1]
    v_pk_fma_f32 v[74:75], v[158:159], v[86:87], v[74:75] op_sel:[1,0,0] op_sel_hi:[1,1,1]
    buffer_load_dwordx4 v[156:159], v0, s[24:27], s28 offen offset:256 nt
    s_waitcnt vmcnt(17)
    v_cvt_f32_i32 v160, v160
    v_cvt_f32_i32 v161, v161
    v_cvt_f32_i32 v162, v162
    v_cvt_f32_i32 v163, v163
    v_pk_fma_f32 v[76:77], v[160:161], v[86:87], v[76:77] op_sel:[0,0,0] op_sel_hi:[0,1,1]
    v_pk_fma_f32 v[78:79], v[160:161], v[86:87], v[78:79] op_sel:[1,0,0] op_sel_hi:[1,1,1]
    v_pk_fma_f32 v[80:81], v[162:163], v[86:87], v[80:81] op_sel:[0,0,0] op_sel_hi:[0,1,1]
    v_pk_fma_f32 v[82:83], v[162:163], v[86:87], v[82:83] op_sel:[1,0,0] op_sel_hi:[1,1,1]
    buffer_load_dwordx4 v[160:163], v0, s[24:27], s28 offen offset:384 nt
    s_add_u32 s28, s28, s69
    s_add_u32 s40, s40, s69
    s_cmp_eq_u32 s29, 1
    s_cbranch_scc1 L_body2
    s_cmp_eq_u32 s29, 2
    s_cbranch_scc1 L_body4
    s_cmp_eq_u32 s29, 4
    s_cbranch_scc1 L_body8
    s_branch L_body2
    s_nop 4
L_last8:
    s_lshr_b32 s58, s68, 1
    s_or_b32 s63, s63, s58
    s_cmp_lg_u32 s63, 0
    s_cbranch_scc1 L_nts8
    s_xor_b32 s62, s66, 1
    s_cmp_lt_u32 s43, s85
    s_cbranch_scc1 L_nts8
    v_mov_b32 v19, 1
    s_mov_b64 exec, 1
    s_add_u32 s67, s62, s73
    s_mul_i32 s58, s62, 4096
    s_add_u32 s58, s58, s94
    buffer_atomic_add v19, v5, s[36:39], s58 offen sc0
    s_mov_b64 exec, -1
    s_nop 4
L_nts8:
    s_waitcnt vmcnt(15)
    v_cvt_f32_i32 v100, v100
    v_cvt_f32_i32 v101, v101
    v_cvt_f32_i32 v102, v102
    v_cvt_f32_i32 v103, v103
    v_pk_fma_f32 v[52:53], v[100:101], v[92:93], v[52:53] op_sel:[0,0,0] op_sel_hi:[0,1,1]
    v_pk_fma_f32 v[54:55], v[100:101], v[92:93], v[54:55] op_sel:[1,0,0] op_sel_hi:[1,1,1]
    v_pk_fma_f32 v[56:57], v[102:103], v[92:93], v[56:57] op_sel:[0,0,0] op_sel_hi:[0,1,1]
    v_pk_fma_f32 v[58:59], v[102:103], v[92:93], v[58:59] op_sel:[1,0,0] op_sel_hi:[1,1,1]
    s_waitcnt vmcnt(14)
    v_cvt_f32_i32 v104, v104
    v_cvt_f32_i32 v105, v105
    v_cvt_f32_i32 v106, v106
    v_cvt_f32_i32 v107, v107
    v_pk_fma_f32 v[60:61], v[104:105], v[92:93], v[60:61] op_sel:[0,0,0] op_sel_hi:[0,1,1]
    v_pk_fma_f32 v[62:63], v[104:105], v[92:93], v[62:63] op_sel:[1,0,0] op_sel_hi:[1,1,1]
    v_pk_fma_f32 v[64:65], v[106:107], v[92:93], v[64:65] op_sel:[0,0,0] op_sel_hi:[0,1,1]
    v_pk_fma_f32 v[66:67], v[106:107], v[92:93], v[66:67] op_sel:[1,0,0] op_sel_hi:[1,1,1]
    s_waitcnt vmcnt(13)
    v_cvt_f32_i32 v108, v108
    v_cvt_f32_i32 v109, v109
    v_cvt_f32_i32 v110, v110
    v_cvt_f32_i32 v111, v111
    v_pk_fma_f32 v[68:69], v[108:109], v[92:93], v[68:69] op_sel:[0,0,0] op_sel_hi:[0,1,1]
    v_pk_fma_f32 v[70:71], v[108:109], v[92:93], v[70:71] op_sel:[1,0,0] op_sel_hi:[1,1,1]
    v_pk_fma_f32 v[72:73], v[110:111], v[92:93], v[72:73] op_sel:[0,0,0] op_sel_hi:[0,1,1]
    v_pk_fma_f32 v[74:75], v[110:111], v[92:93], v[74:75] op_sel:[1,0,0] op_sel_hi:[1,1,1]
    s_waitcnt vmcnt(12)
    v_cvt_f32_i32 v112, v112
    v_cvt_f32_i32 v113, v113
    v_cvt_f32_i32 v114, v114
    v_cvt_f32_i32 v115, v115
    v_pk_fma_f32 v[76:77], v[112:113], v[92:93], v[76:77] op_sel:[0,0,0] op_sel_hi:[0,1,1]
    v_pk_fma_f32 v[78:79], v[112:113], v[92:93], v[78:79] op_sel:[1,0,0] op_sel_hi:[1,1,1]
    v_pk_fma_f32 v[80:81], v[114:115], v[92:93], v[80:81] op_sel:[0,0,0] op_sel_hi:[0,1,1]
    v_pk_fma_f32 v[82:83], v[114:115], v[92:93], v[82:83] op_sel:[1,0,0] op_sel_hi:[1,1,1]
    s_waitcnt vmcnt(11)
    v_cvt_f32_i32 v116, v116
    v_cvt_f32_i32 v117, v117
    v_cvt_f32_i32 v118, v118
    v_cvt_f32_i32 v119, v119
    v_pk_fma_f32 v[52:53], v[116:117], v[94:95], v[52:53] op_sel:[0,0,0] op_sel_hi:[0,1,1]
    v_pk_fma_f32 v[54:55], v[116:117], v[94:95], v[54:55] op_sel:[1,0,0] op_sel_hi:[1,1,1]
    v_pk_fma_f32 v[56:57], v[118:119], v[94:95], v[56:57] op_sel:[0,0,0] op_sel_hi:[0,1,1]
    v_pk_fma_f32 v[58:59], v[118:119], v[94:95], v[58:59] op_sel:[1,0,0] op_sel_hi:[1,1,1]
    s_waitcnt vmcnt(10)
    v_cvt_f32_i32 v120, v120
    v_cvt_f32_i32 v121, v121
    v_cvt_f32_i32 v122, v122
    v_cvt_f32_i32 v123, v123
    v_pk_fma_f32 v[60:61], v[120:121], v[94:95], v[60:61] op_sel:[0,0,0] op_sel_hi:[0,1,1]
    v_pk_fma_f32 v[62:63], v[120:121], v[94:95], v[62:63] op_sel:[1,0,0] op_sel_hi:[1,1,1]
    v_pk_fma_f32 v[64:65], v[122:123], v[94:95], v[64:65] op_sel:[0,0,0] op_sel_hi:[0,1,1]
    v_pk_fma_f32 v[66:67], v[122:123], v[94:95], v[66:67] op_sel:[1,0,0] op_sel_hi:[1,1,1]
    s_waitcnt vmcnt(9)
    v_cvt_f32_i32 v124, v124
    v_cvt_f32_i32 v125, v125
    v_cvt_f32_i32 v126, v126
    v_cvt_f32_i32 v127, v127
    v_pk_fma_f32 v[68:69], v[124:125], v[94:95], v[68:69] op_sel:[0,0,0] op_sel_hi:[0,1,1]
    v_pk_fma_f32 v[70:71], v[124:125], v[94:95], v[70:71] op_sel:[1,0,0] op_sel_hi:[1,1,1]
    v_pk_fma_f32 v[72:73], v[126:127], v[94:95], v[72:73] op_sel:[0,0,0] op_sel_hi:[0,1,1]
    v_pk_fma_f32 v[74:75], v[126:127], v[94:95], v[74:75] op_sel:[1,0,0] op_sel_hi:[1,1,1]
    s_waitcnt vmcnt(8)
    v_cvt_f32_i32 v128, v128
    v_cvt_f32_i32 v129, v129
    v_cvt_f32_i32 v130, v130
    v_cvt_f32_i32 v131, v131
    v_pk_fma_f32 v[76:77], v[128:129], v[94:95], v[76:77] op_sel:[0,0,0] op_sel_hi:[0,1,1]
    v_pk_fma_f32 v[78:79], v[128:129], v[94:95], v[78:79] op_sel:[1,0,0] op_sel_hi:[1,1,1]
    v_pk_fma_f32 v[80:81], v[130:131], v[94:95], v[80:81] op_sel:[0,0,0] op_sel_hi:[0,1,1]
    v_pk_fma_f32 v[82:83], v[130:131], v[94:95], v[82:83] op_sel:[1,0,0] op_sel_hi:[1,1,1]
    s_barrier
    s_waitcnt vmcnt(7)
    v_cvt_f32_i32 v132, v132
    v_cvt_f32_i32 v133, v133
    v_cvt_f32_i32 v134, v134
    v_cvt_f32_i32 v135, v135
    v_pk_fma_f32 v[52:53], v[132:133], v[96:97], v[52:53] op_sel:[0,0,0] op_sel_hi:[0,1,1]
    v_pk_fma_f32 v[54:55], v[132:133], v[96:97], v[54:55] op_sel:[1,0,0] op_sel_hi:[1,1,1]
    v_pk_fma_f32 v[56:57], v[134:135], v[96:97], v[56:57] op_sel:[0,0,0] op_sel_hi:[0,1,1]
    v_pk_fma_f32 v[58:59], v[134:135], v[96:97], v[58:59] op_sel:[1,0,0] op_sel_hi:[1,1,1]
    s_waitcnt vmcnt(6)
    v_cvt_f32_i32 v136, v136
    v_cvt_f32_i32 v137, v137
    v_cvt_f32_i32 v138, v138
    v_cvt_f32_i32 v139, v139
    v_pk_fma_f32 v[60:61], v[136:137], v[96:97], v[60:61] op_sel:[0,0,0] op_sel_hi:[0,1,1]
    v_pk_fma_f32 v[62:63], v[136:137], v[96:97], v[62:63] op_sel:[1,0,0] op_sel_hi:[1,1,1]
    v_pk_fma_f32 v[64:65], v[138:139], v[96:97], v[64:65] op_sel:[0,0,0] op_sel_hi:[0,1,1]
    v_pk_fma_f32 v[66:67], v[138:139], v[96:97], v[66:67] op_sel:[1,0,0] op_sel_hi:[1,1,1]
    s_waitcnt vmcnt(5)
    v_cvt_f32_i32 v140, v140
    v_cvt_f32_i32 v141, v141
    v_cvt_f32_i32 v142, v142
    v_cvt_f32_i32 v143, v143
    v_pk_fma_f32 v[68:69], v[140:141], v[96:97], v[68:69] op_sel:[0,0,0] op_sel_hi:[0,1,1]
    v_pk_fma_f32 v[70:71], v[140:141], v[96:97], v[70:71] op_sel:[1,0,0] op_sel_hi:[1,1,1]
    v_pk_fma_f32 v[72:73], v[142:143], v[96:97], v[72:73] op_sel:[0,0,0] op_sel_hi:[0,1,1]
    v_pk_fma_f32 v[74:75], v[142:143], v[96:97], v[74:75] op_sel:[1,0,0] op_sel_hi:[1,1,1]
    s_waitcnt vmcnt(4)
    v_cvt_f32_i32 v144, v144
    v_cvt_f32_i32 v145, v145
    v_cvt_f32_i32 v146, v146
    v_cvt_f32_i32 v147, v147
    v_pk_fma_f32 v[76:77], v[144:145], v[96:97], v[76:77] op_sel:[0,0,0] op_sel_hi:[0,1,1]
    v_pk_fma_f32 v[78:79], v[144:145], v[96:97], v[78:79] op_sel:[1,0,0] op_sel_hi:[1,1,1]
    v_pk_fma_f32 v[80:81], v[146:147], v[96:97], v[80:81] op_sel:[0,0,0] op_sel_hi:[0,1,1]
    v_pk_fma_f32 v[82:83], v[146:147], v[96:97], v[82:83] op_sel:[1,0,0] op_sel_hi:[1,1,1]
    s_waitcnt vmcnt(3)
    v_cvt_f32_i32 v148, v148
    v_cvt_f32_i32 v149, v149
    v_cvt_f32_i32 v150, v150
    v_cvt_f32_i32 v151, v151
    v_pk_fma_f32 v[52:53], v[148:149], v[98:99], v[52:53] op_sel:[0,0,0] op_sel_hi:[0,1,1]
    v_pk_fma_f32 v[54:55], v[148:149], v[98:99], v[54:55] op_sel:[1,0,0] op_sel_hi:[1,1,1]
    v_pk_fma_f32 v[56:57], v[150:151], v[98:99], v[56:57] op_sel:[0,0,0] op_sel_hi:[0,1,1]
    v_pk_fma_f32 v[58:59], v[150:151], v[98:99], v[58:59] op_sel:[1,0,0] op_sel_hi:[1,1,1]
    s_waitcnt vmcnt(2)
    v_cvt_f32_i32 v152, v152
    v_cvt_f32_i32 v153, v153
    v_cvt_f32_i32 v154, v154
    v_cvt_f32_i32 v155, v155
    v_pk_fma_f32 v[60:61], v[152:153], v[98:99], v[60:61] op_sel:[0,0,0] op_sel_hi:[0,1,1]
    v_pk_fma_f32 v[62:63], v[152:153], v[98:99], v[62:63] op_sel:[1,0,0] op_sel_hi:[1,1,1]
    v_pk_fma_f32 v[64:65], v[154:155], v[98:99], v[64:65] op_sel:[0,0,0] op_sel_hi:[0,1,1]
    v_pk_fma_f32 v[66:67], v[154:155], v[98:99], v[66:67] op_sel:[1,0,0] op_sel_hi:[1,1,1]
    s_waitcnt vmcnt(1)
    v_cvt_f32_i32 v156, v156
    v_cvt_f32_i32 v157, v157
    v_cvt_f32_i32 v158, v158
    v_cvt_f32_i32 v159, v159
    v_pk_fma_f32 v[68:69], v[156:157], v[98:99], v[68:69] op_sel:[0,0,0] op_sel_hi:[0,1,1]
    v_pk_fma_f32 v[70:71], v[156:157], v[98:99], v[70:71] op_sel:[1,0,0] op_sel_hi:[1,1,1]
    v_pk_fma_f32 v[72:73], v[158:159], v[98:99], v[72:73] op_sel:[0,0,0] op_sel_hi:[0,1,1]
    v_pk_fma_f32 v[74:75], v[158:159], v[98:99], v[74:75] op_sel:[1,0,0] op_sel_hi:[1,1,1]
    s_waitcnt vmcnt(0)
    v_cvt_f32_i32 v160, v160
    v_cvt_f32_i32 v161, v161
    v_cvt_f32_i32 v162, v162
    v_cvt_f32_i32 v163, v163
    v_pk_fma_f32 v[76:77], v[160:161], v[98:99], v[76:77] op_sel:[0,0,0] op_sel_hi:[0,1,1]
    v_pk_fma_f32 v[78:79], v[160:161], v[98:99], v[78:79] op_sel:[1,0,0] op_sel_hi:[1,1,1]
    v_pk_fma_f32 v[80:81], v[162:163], v[98:99], v[80:81] op_sel:[0,0,0] op_sel_hi:[0,1,1]
    v_pk_fma_f32 v[82:83], v[162:163], v[98:99], v[82:83] op_sel:[1,0,0] op_sel_hi:[1,1,1]
    s_branch L_sw
    s_nop 4
L_last4:
    s_lshr_b32 s58, s68, 1
    s_or_b32 s63, s63, s58
    s_cmp_lg_u32 s63, 0
    s_cbranch_scc1 L_nts4
    s_xor_b32 s62, s66, 1
    s_cmp_lt_u32 s43, s85
    s_cbranch_scc1 L_nts4
    v_mov_b32 v19, 1
    s_mov_b64 exec, 1
    s_add_u32 s67, s62, s73
    s_mul_i32 s58, s62, 4096
    s_add_u32 s58, s58, s94
    buffer_atomic_add v19, v5, s[36:39], s58 offen sc0
    s_mov_b64 exec, -1
    s_nop 4
L_nts4:
    s_waitcnt lgkmcnt(0)
    v_mov_b32 v6, v84
    v_mov_b32 v7, v85
    v_lshlrev_b32 v12, 16, v12
    v_lshlrev_b32 v13, 16, v13
    v_permlane32_swap_b32 v6, v7
    v_max_f32 v6, v6, v7
    v_mov_b32 v7, v6
    s_nop 1
    v_permlane16_swap_b32 v6, v7
    v_max_f32 v6, v6, v7
    s_nop 1
    v_max_f32_dpp v6, v6, v6 row_ror:8 row_mask:0xf bank_mask:0xf
    s_nop 1
    v_max_f32_dpp v6, v6, v6 row_ror:4 row_mask:0xf bank_mask:0xf
    s_nop 1
    v_max_f32_dpp v6, v6, v6 row_ror:2 row_mask:0xf bank_mask:0xf
    s_nop 1
    v_max_f32_dpp v6, v6, v6 row_ror:1 row_mask:0xf bank_mask:0xf
    v_max_f32 v6, v6, v4
    v_sub_f32 v7, v4, v6
    v_exp_f32 v7, v7
    v_mov_b32 v4, v6
    v_readlane_b32 s48, v6, 0
    v_readlane_b32 s49, v6, 32
    v_readlane_b32 s50, v7, 0
    v_readlane_b32 s51, v7, 32
    v_subrev_f32 v14, s48, v84
    v_subrev_f32 v15, s49, v85
    v_exp_f32 v14, v14
    v_exp_f32 v15, v15
    v_cndmask_b32 v14, v14, 0, s[46:47]
    v_cndmask_b32 v15, v15, 0, s[46:47]
    v_pk_mul_f32 v[10:11], v[10:11], s[50:51]
    v_pk_mul_f32 v[16:17], v[14:15], v[12:13] op_sel:[0,0] op_sel_hi:[1,0]
    v_pk_fma_f32 v[8:9], v[8:9], s[50:51], v[14:15]
    ds_write_b64 v2, v[16:17]
    v_pk_fma_f32 v[10:11], v[16:17], v[12:13], v[10:11] op_sel:[0,1,0] op_sel_hi:[1,1,1]
    ds_read_b128 v[84:87], v3 offset:0
    ds_read_b128 v[88:91], v3 offset:16
    v_pk_mul_f32 v[52:53], v[52:53], s[50:51]
    v_pk_mul_f32 v[54:55], v[54:55], s[50:51]
    v_pk_mul_f32 v[56:57], v[56:57], s[50:51]
    v_pk_mul_f32 v[58:59], v[58:59], s[50:51]
    v_pk_mul_f32 v[60:61], v[60:61], s[50:51]
    v_pk_mul_f32 v[62:63], v[62:63], s[50:51]
    v_pk_mul_f32 v[64:65], v[64:65], s[50:51]
    v_pk_mul_f32 v[66:67], v[66:67], s[50:51]
    v_pk_mul_f32 v[68:69], v[68:69], s[50:51]
    v_pk_mul_f32 v[70:71], v[70:71], s[50:51]
    v_pk_mul_f32 v[72:73], v[72:73], s[50:51]
    v_pk_mul_f32 v[74:75], v[74:75], s[50:51]
    v_pk_mul_f32 v[76:77], v[76:77], s[50:51]
    v_pk_mul_f32 v[78:79], v[78:79], s[50:51]
    v_pk_mul_f32 v[80:81], v[80:81], s[50:51]
    v_pk_mul_f32 v[82:83], v[82:83], s[50:51]
    s_waitcnt lgkmcnt(0)
    s_waitcnt vmcnt(15)
    v_cvt_f32_i32 v100, v100
    v_cvt_f32_i32 v101, v101
    v_cvt_f32_i32 v102, v102
    v_cvt_f32_i32 v103, v103
    v_pk_fma_f32 v[52:53], v[100:101], v[84:85], v[52:53] op_sel:[0,0,0] op_sel_hi:[0,1,1]
    v_pk_fma_f32 v[54:55], v[100:101], v[84:85], v[54:55] op_sel:[1,0,0] op_sel_hi:[1,1,1]
    v_pk_fma_f32 v[56:57], v[102:103], v[84:85], v[56:57] op_sel:[0,0,0] op_sel_hi:[0,1,1]
    v_pk_fma_f32 v[58:59], v[102:103], v[84:85], v[58:59] op_sel:[1,0,0] op_sel_hi:[1,1,1]
    s_waitcnt vmcnt(14)
    v_cvt_f32_i32 v104, v104
    v_cvt_f32_i32 v105, v105
    v_cvt_f32_i32 v106, v106
    v_cvt_f32_i32 v107, v107
    v_pk_fma_f32 v[60:61], v[104:105], v[84:85], v[60:61] op_sel:[0,0,0] op_sel_hi:[0,1,1]
    v_pk_fma_f32 v[62:63], v[104:105], v[84:85], v[62:63] op_sel:[1,0,0] op_sel_hi:[1,1,1]
    v_pk_fma_f32 v[64:65], v[106:107], v[84:85], v[64:65] op_sel:[0,0,0] op_sel_hi:[0,1,1]
    v_pk_fma_f32 v[66:67], v[106:107], v[84:85], v[66:67] op_sel:[1,0,0] op_sel_hi:[1,1,1]
    s_waitcnt vmcnt(13)
    v_cvt_f32_i32 v108, v108
    v_cvt_f32_i32 v109, v109
    v_cvt_f32_i32 v110, v110
    v_cvt_f32_i32 v111, v111
    v_pk_fma_f32 v[68:69], v[108:109], v[84:85], v[68:69] op_sel:[0,0,0] op_sel_hi:[0,1,1]
    v_pk_fma_f32 v[70:71], v[108:109], v[84:85], v[70:71] op_sel:[1,0,0] op_sel_hi:[1,1,1]
    v_pk_fma_f32 v[72:73], v[110:111], v[84:85], v[72:73] op_sel:[0,0,0] op_sel_hi:[0,1,1]
    v_pk_fma_f32 v[74:75], v[110:111], v[84:85], v[74:75] op_sel:[1,0,0] op_sel_hi:[1,1,1]
    s_waitcnt vmcnt(12)
    v_cvt_f32_i32 v112, v112
    v_cvt_f32_i32 v113, v113
    v_cvt_f32_i32 v114, v114
    v_cvt_f32_i32 v115, v115
    v_pk_fma_f32 v[76:77], v[112:113], v[84:85], v[76:77] op_sel:[0,0,0] op_sel_hi:[0,1,1]
    v_pk_fma_f32 v[78:79], v[112:113], v[84:85], v[78:79] op_sel:[1,0,0] op_sel_hi:[1,1,1]
    v_pk_fma_f32 v[80:81], v[114:115], v[84:85], v[80:81] op_sel:[0,0,0] op_sel_hi:[0,1,1]
    v_pk_fma_f32 v[82:83], v[114:115], v[84:85], v[82:83] op_sel:[1,0,0] op_sel_hi:[1,1,1]
    s_waitcnt vmcnt(11)
    v_cvt_f32_i32 v116, v116
    v_cvt_f32_i32 v117, v117
    v_cvt_f32_i32 v118, v118
    v_cvt_f32_i32 v119, v119
    v_pk_fma_f32 v[52:53], v[116:117], v[86:87], v[52:53] op_sel:[0,0,0] op_sel_hi:[0,1,1]
    v_pk_fma_f32 v[54:55], v[116:117], v[86:87], v[54:55] op_sel:[1,0,0] op_sel_hi:[1,1,1]
    v_pk_fma_f32 v[56:57], v[118:119], v[86:87], v[56:57] op_sel:[0,0,0] op_sel_hi:[0,1,1]
    v_pk_fma_f32 v[58:59], v[118:119], v[86:87], v[58:59] op_sel:[1,0,0] op_sel_hi:[1,1,1]
    s_waitcnt vmcnt(10)
    v_cvt_f32_i32 v120, v120
    v_cvt_f32_i32 v121, v121
    v_cvt_f32_i32 v122, v122
    v_cvt_f32_i32 v123, v123
    v_pk_fma_f32 v[60:61], v[120:121], v[86:87], v[60:61] op_sel:[0,0,0] op_sel_hi:[0,1,1]
    v_pk_fma_f32 v[62:63], v[120:121], v[86:87], v[62:63] op_sel:[1,0,0] op_sel_hi:[1,1,1]
    v_pk_fma_f32 v[64:65], v[122:123], v[86:87], v[64:65] op_sel:[0,0,0] op_sel_hi:[0,1,1]
    v_pk_fma_f32 v[66:67], v[122:123], v[86:87], v[66:67] op_sel:[1,0,0] op_sel_hi:[1,1,1]
    s_waitcnt vmcnt(9)
    v_cvt_f32_i32 v124, v124
    v_cvt_f32_i32 v125, v125
    v_cvt_f32_i32 v126, v126
    v_cvt_f32_i32 v127, v127
    v_pk_fma_f32 v[68:69], v[124:125], v[86:87], v[68:69] op_sel:[0,0,0] op_sel_hi:[0,1,1]
    v_pk_fma_f32 v[70:71], v[124:125], v[86:87], v[70:71] op_sel:[1,0,0] op_sel_hi:[1,1,1]
    v_pk_fma_f32 v[72:73], v[126:127], v[86:87], v[72:73] op_sel:[0,0,0] op_sel_hi:[0,1,1]
    v_pk_fma_f32 v[74:75], v[126:127], v[86:87], v[74:75] op_sel:[1,0,0] op_sel_hi:[1,1,1]
    s_waitcnt vmcnt(8)
    v_cvt_f32_i32 v128, v128
    v_cvt_f32_i32 v129, v129
    v_cvt_f32_i32 v130, v130
    v_cvt_f32_i32 v131, v131
    v_pk_fma_f32 v[76:77], v[128:129], v[86:87], v[76:77] op_sel:[0,0,0] op_sel_hi:[0,1,1]
    v_pk_fma_f32 v[78:79], v[128:129], v[86:87], v[78:79] op_sel:[1,0,0] op_sel_hi:[1,1,1]
    v_pk_fma_f32 v[80:81], v[130:131], v[86:87], v[80:81] op_sel:[0,0,0] op_sel_hi:[0,1,1]
    v_pk_fma_f32 v[82:83], v[130:131], v[86:87], v[82:83] op_sel:[1,0,0] op_sel_hi:[1,1,1]
    s_barrier
    s_waitcnt vmcnt(7)
    v_cvt_f32_i32 v132, v132
    v_cvt_f32_i32 v133, v133
    v_cvt_f32_i32 v134, v134
    v_cvt_f32_i32 v135, v135
    v_pk_fma_f32 v[52:53], v[132:133], v[88:89], v[52:53] op_sel:[0,0,0] op_sel_hi:[0,1,1]
    v_pk_fma_f32 v[54:55], v[132:133], v[88:89], v[54:55] op_sel:[1,0,0] op_sel_hi:[1,1,1]
    v_pk_fma_f32 v[56:57], v[134:135], v[88:89], v[56:57] op_sel:[0,0,0] op_sel_hi:[0,1,1]
    v_pk_fma_f32 v[58:59], v[134:135], v[88:89], v[58:59] op_sel:[1,0,0] op_sel_hi:[1,1,1]
    s_waitcnt vmcnt(6)
    v_cvt_f32_i32 v136, v136
    v_cvt_f32_i32 v137, v137
    v_cvt_f32_i32 v138, v138
    v_cvt_f32_i32 v139, v139
    v_pk_fma_f32 v[60:61], v[136:137], v[88:89], v[60:61] op_sel:[0,0,0] op_sel_hi:[0,1,1]
    v_pk_fma_f32 v[62:63], v[136:137], v[88:89], v[62:63] op_sel:[1,0,0] op_sel_hi:[1,1,1]
    v_pk_fma_f32 v[64:65], v[138:139], v[88:89], v[64:65] op_sel:[0,0,0] op_sel_hi:[0,1,1]
    v_pk_fma_f32 v[66:67], v[138:139], v[88:89], v[66:67] op_sel:[1,0,0] op_sel_hi:[1,1,1]
    s_waitcnt vmcnt(5)
    v_cvt_f32_i32 v140, v140
    v_cvt_f32_i32 v141, v141
    v_cvt_f32_i32 v142, v142
    v_cvt_f32_i32 v143, v143
    v_pk_fma_f32 v[68:69], v[140:141], v[88:89], v[68:69] op_sel:[0,0,0] op_sel_hi:[0,1,1]
    v_pk_fma_f32 v[70:71], v[140:141], v[88:89], v[70:71] op_sel:[1,0,0] op_sel_hi:[1,1,1]
    v_pk_fma_f32 v[72:73], v[142:143], v[88:89], v[72:73] op_sel:[0,0,0] op_sel_hi:[0,1,1]
    v_pk_fma_f32 v[74:75], v[142:143], v[88:89], v[74:75] op_sel:[1,0,0] op_sel_hi:[1,1,1]
    s_waitcnt vmcnt(4)
    v_cvt_f32_i32 v144, v144
    v_cvt_f32_i32 v145, v145
    v_cvt_f32_i32 v146, v146
    v_cvt_f32_i32 v147, v147
    v_pk_fma_f32 v[76:77], v[144:145], v[88:89], v[76:77] op_sel:[0,0,0] op_sel_hi:[0,1,1]
    v_pk_fma_f32 v[78:79], v[144:145], v[88:89], v[78:79] op_sel:[1,0,0] op_sel_hi:[1,1,1]
    v_pk_fma_f32 v[80:81], v[146:147], v[88:89], v[80:81] op_sel:[0,0,0] op_sel_hi:[0,1,1]
    v_pk_fma_f32 v[82:83], v[146:147], v[88:89], v[82:83] op_sel:[1,0,0] op_sel_hi:[1,1,1]
    s_waitcnt vmcnt(3)
    v_cvt_f32_i32 v148, v148
    v_cvt_f32_i32 v149, v149
    v_cvt_f32_i32 v150, v150
    v_cvt_f32_i32 v151, v151
    v_pk_fma_f32 v[52:53], v[148:149], v[90:91], v[52:53] op_sel:[0,0,0] op_sel_hi:[0,1,1]
    v_pk_fma_f32 v[54:55], v[148:149], v[90:91], v[54:55] op_sel:[1,0,0] op_sel_hi:[1,1,1]
    v_pk_fma_f32 v[56:57], v[150:151], v[90:91], v[56:57] op_sel:[0,0,0] op_sel_hi:[0,1,1]
    v_pk_fma_f32 v[58:59], v[150:151], v[90:91], v[58:59] op_sel:[1,0,0] op_sel_hi:[1,1,1]
    s_waitcnt vmcnt(2)
    v_cvt_f32_i32 v152, v152
    v_cvt_f32_i32 v153, v153
    v_cvt_f32_i32 v154, v154
    v_cvt_f32_i32 v155, v155
    v_pk_fma_f32 v[60:61], v[152:153], v[90:91], v[60:61] op_sel:[0,0,0] op_sel_hi:[0,1,1]
    v_pk_fma_f32 v[62:63], v[152:153], v[90:91], v[62:63] op_sel:[1,0,0] op_sel_hi:[1,1,1]
    v_pk_fma_f32 v[64:65], v[154:155], v[90:91], v[64:65] op_sel:[0,0,0] op_sel_hi:[0,1,1]
    v_pk_fma_f32 v[66:67], v[154:155], v[90:91], v[66:67] op_sel:[1,0,0] op_sel_hi:[1,1,1]
    s_waitcnt vmcnt(1)
    v_cvt_f32_i32 v156, v156
    v_cvt_f32_i32 v157, v157
    v_cvt_f32_i32 v158, v158
    v_cvt_f32_i32 v159, v159
    v_pk_fma_f32 v[68:69], v[156:157], v[90:91], v[68:69] op_sel:[0,0,0] op_sel_hi:[0,1,1]
    v_pk_fma_f32 v[70:71], v[156:157], v[90:91], v[70:71] op_sel:[1,0,0] op_sel_hi:[1,1,1]
    v_pk_fma_f32 v[72:73], v[158:159], v[90:91], v[72:73] op_sel:[0,0,0] op_sel_hi:[0,1,1]
    v_pk_fma_f32 v[74:75], v[158:159], v[90:91], v[74:75] op_sel:[1,0,0] op_sel_hi:[1,1,1]
    s_waitcnt vmcnt(0)
    v_cvt_f32_i32 v160, v160
    v_cvt_f32_i32 v161, v161
    v_cvt_f32_i32 v162, v162
    v_cvt_f32_i32 v163, v163
    v_pk_fma_f32 v[76:77], v[160:161], v[90:91], v[76:77] op_sel:[0,0,0] op_sel_hi:[0,1,1]
    v_pk_fma_f32 v[78:79], v[160:161], v[90:91], v[78:79] op_sel:[1,0,0] op_sel_hi:[1,1,1]
    v_pk_fma_f32 v[80:81], v[162:163], v[90:91], v[80:81] op_sel:[0,0,0] op_sel_hi:[0,1,1]
    v_pk_fma_f32 v[82:83], v[162:163], v[90:91], v[82:83] op_sel:[1,0,0] op_sel_hi:[1,1,1]
    s_branch L_sw
    s_nop 4
L_last2:
    s_lshr_b32 s58, s68, 1
    s_or_b32 s63, s63, s58
    s_cmp_lg_u32 s63, 0
    s_cbranch_scc1 L_nts2
    s_xor_b32 s62, s66, 1
    s_cmp_lt_u32 s43, s85
    s_cbranch_scc1 L_nts2
    v_mov_b32 v19, 1
    s_mov_b64 exec, 1
    s_add_u32 s67, s62, s73
    s_mul_i32 s58, s62, 4096
    s_add_u32 s58, s58, s94
    buffer_atomic_add v19, v5, s[36:39], s58 offen sc0
    s_mov_b64 exec, -1
    s_nop 4
L_nts2:
    s_waitcnt vmcnt(14)
    v_cvt_f32_i32 v104, v104
    v_cvt_f32_i32 v105, v105
    v_cvt_f32_i32 v106, v106
    v_cvt_f32_i32 v107, v107
    v_pk_fma_f32 v[84:85], v[104:105], v[28:29], v[84:85] op_sel:[0,0,0] op_sel_hi:[0,1,1]
    v_pk_fma_f32 v[84:85], v[104:105], v[30:31], v[84:85] op_sel:[1,0,0] op_sel_hi:[1,1,1]
    v_pk_fma_f32 v[84:85], v[106:107], v[32:33], v[84:85] op_sel:[0,0,0] op_sel_hi:[0,1,1]
    v_pk_fma_f32 v[84:85], v[106:107], v[34:35], v[84:85] op_sel:[1,0,0] op_sel_hi:[1,1,1]
    s_waitcnt vmcnt(13)
    v_cvt_f32_i32 v108, v108
    v_cvt_f32_i32 v109, v109
    v_cvt_f32_i32 v110, v110
    v_cvt_f32_i32 v111, v111
    v_pk_fma_f32 v[84:85], v[108:109], v[36:37], v[84:85] op_sel:[0,0,0] op_sel_hi:[0,1,1]
    v_pk_fma_f32 v[84:85], v[108:109], v[38:39], v[84:85] op_sel:[1,0,0] op_sel_hi:[1,1,1]
    v_pk_fma_f32 v[84:85], v[110:111], v[40:41], v[84:85] op_sel:[0,0,0] op_sel_hi:[0,1,1]
    v_pk_fma_f32 v[84:85], v[110:111], v[42:43], v[84:85] op_sel:[1,0,0] op_sel_hi:[1,1,1]
    s_waitcnt vmcnt(12)
    v_cvt_f32_i32 v112, v112
    v_cvt_f32_i32 v113, v113
    v_cvt_f32_i32 v114, v114
    v_cvt_f32_i32 v115, v115
    v_pk_fma_f32 v[84:85], v[112:113], v[44:45], v[84:85] op_sel:[0,0,0] op_sel_hi:[0,1,1]
    v_pk_fma_f32 v[84:85], v[112:113], v[46:47], v[84:85] op_sel:[1,0,0] op_sel_hi:[1,1,1]
    v_pk_fma_f32 v[84:85], v[114:115], v[48:49], v[84:85] op_sel:[0,0,0] op_sel_hi:[0,1,1]
    v_pk_fma_f32 v[84:85], v[114:115], v[50:51], v[84:85] op_sel:[1,0,0] op_sel_hi:[1,1,1]
    s_waitcnt vmcnt(11)
    v_cvt_f32_i32 v116, v116
    v_cvt_f32_i32 v117, v117
    v_cvt_f32_i32 v118, v118
    v_cvt_f32_i32 v119, v119
    v_pk_mul_f32 v[86:87], v[116:117], v[20:21] op_sel:[0,0] op_sel_hi:[0,1]
    v_pk_fma_f32 v[86:87], v[116:117], v[22:23], v[86:87] op_sel:[1,0,0] op_sel_hi:[1,1,1]
    v_pk_fma_f32 v[86:87], v[118:119], v[24:25], v[86:87] op_sel:[0,0,0] op_sel_hi:[0,1,1]
    v_pk_fma_f32 v[86:87], v[118:119], v[26:27], v[86:87] op_sel:[1,0,0] op_sel_hi:[1,1,1]
    s_waitcnt vmcnt(10)
    v_cvt_f32_i32 v120, v120
    v_cvt_f32_i32 v121, v121
    v_cvt_f32_i32 v122, v122
    v_cvt_f32_i32 v123, v123
    v_pk_fma_f32 v[86:87], v[120:121], v[28:29], v[86:87] op_sel:[0,0,0] op_sel_hi:[0,1,1]
    v_pk_fma_f32 v[86:87], v[120:121], v[30:31], v[86:87] op_sel:[1,0,0] op_sel_hi:[1,1,1]
    v_pk_fma_f32 v[86:87], v[122:123], v[32:33], v[86:87] op_sel:[0,0,0] op_sel_hi:[0,1,1]
    v_pk_fma_f32 v[86:87], v[122:123], v[34:35], v[86:87] op_sel:[1,0,0] op_sel_hi:[1,1,1]
    s_waitcnt vmcnt(9)
    v_cvt_f32_i32 v124, v124
    v_cvt_f32_i32 v125, v125
    v_cvt_f32_i32 v126, v126
    v_cvt_f32_i32 v127, v127
    v_pk_fma_f32 v[86:87], v[124:125], v[36:37], v[86:87] op_sel:[0,0,0] op_sel_hi:[0,1,1]
    v_pk_fma_f32 v[86:87], v[124:125], v[38:39], v[86:87] op_sel:[1,0,0] op_sel_hi:[1,1,1]
    v_pk_fma_f32 v[86:87], v[126:127], v[40:41], v[86:87] op_sel:[0,0,0] op_sel_hi:[0,1,1]
    v_pk_fma_f32 v[86:87], v[126:127], v[42:43], v[86:87] op_sel:[1,0,0] op_sel_hi:[1,1,1]
    s_waitcnt vmcnt(8)
    v_cvt_f32_i32 v128, v128
    v_cvt_f32_i32 v129, v129
    v_cvt_f32_i32 v130, v130
    v_cvt_f32_i32 v131, v131
    v_pk_fma_f32 v[86:87], v[128:129], v[44:45], v[86:87] op_sel:[0,0,0] op_sel_hi:[0,1,1]
    v_pk_fma_f32 v[86:87], v[128:129], v[46:47], v[86:87] op_sel:[1,0,0] op_sel_hi:[1,1,1]
    v_pk_fma_f32 v[86:87], v[130:131], v[48:49], v[86:87] op_sel:[0,0,0] op_sel_hi:[0,1,1]
    v_pk_fma_f32 v[86:87], v[130:131], v[50:51], v[86:87] op_sel:[1,0,0] op_sel_hi:[1,1,1]
    v_add_f32_dpp v84, v84, v84 row_half_mirror row_mask:0xf bank_mask:0x5
    v_add_f32_dpp v85, v85, v85 row_half_mirror row_mask:0xf bank_mask:0x5
    s_nop 0
    v_add_f32_dpp v84, v86, v86 row_half_mirror row_mask:0xf bank_mask:0xa
    v_add_f32_dpp v85, v87, v87 row_half_mirror row_mask:0xf bank_mask:0xa
    s_nop 0
    v_add_f32_dpp v84, v84, v84 quad_perm:[2,3,0,1] row_mask:0xf bank_mask:0xf
    v_add_f32_dpp v85, v85, v85 quad_perm:[2,3,0,1] row_mask:0xf bank_mask:0xf
    s_nop 0
    v_add_f32_dpp v84, v84, v84 quad_perm:[1,0,3,2] row_mask:0xf bank_mask:0xf
    v_add_f32_dpp v85, v85, v85 quad_perm:[1,0,3,2] row_mask:0xf bank_mask:0xf
    s_barrier
    s_waitcnt lgkmcnt(0)
    v_mov_b32 v6, v84
    v_mov_b32 v7, v85
    v_lshlrev_b32 v12, 16, v12
    v_lshlrev_b32 v13, 16, v13
    v_permlane32_swap_b32 v6, v7
    v_max_f32 v6, v6, v7
    v_mov_b32 v7, v6
    s_nop 1
    v_permlane16_swap_b32 v6, v7
    v_max_f32 v6, v6, v7
    s_nop 1
    v_max_f32_dpp v6, v6, v6 row_ror:8 row_mask:0xf bank_mask:0xf
    s_nop 1
    v_max_f32_dpp v6, v6, v6 row_ror:4 row_mask:0xf bank_mask:0xf
    s_nop 1
    v_max_f32_dpp v6, v6, v6 row_ror:2 row_mask:0xf bank_mask:0xf
    s_nop 1
    v_max_f32_dpp v6, v6, v6 row_ror:1 row_mask:0xf bank_mask:0xf
    v_max_f32 v6, v6, v4
    v_sub_f32 v7, v4, v6
    v_exp_f32 v7, v7
    v_mov_b32 v4, v6
    v_readlane_b32 s48, v6, 0
    v_readlane_b32 s49, v6, 32
    v_readlane_b32 s50, v7, 0
    v_readlane_b32 s51, v7, 32
    v_subrev_f32 v14, s48, v84
    v_subrev_f32 v15, s49, v85
    v_exp_f32 v14, v14
    v_exp_f32 v15, v15
    v_cndmask_b32 v14, v14, 0, s[32:33]
    v_cndmask_b32 v15, v15, 0, s[32:33]
    v_pk_mul_f32 v[10:11], v[10:11], s[50:51]
    v_pk_mul_f32 v[16:17], v[14:15], v[12:13] op_sel:[0,0] op_sel_hi:[1,0]
    v_pk_fma_f32 v[8:9], v[8:9], s[50:51], v[14:15]
    ds_write_b64 v2, v[16:17]
    v_pk_fma_f32 v[10:11], v[16:17], v[12:13], v[10:11] op_sel:[0,1,0] op_sel_hi:[1,1,1]
    ds_read_b128 v[84:87], v3 offset:0
    v_pk_mul_f32 v[52:53], v[52:53], s[50:51]
    v_pk_mul_f32 v[54:55], v[54:55], s[50:51]
    v_pk_mul_f32 v[56:57], v[56:57], s[50:51]
    v_pk_mul_f32 v[58:59], v[58:59], s[50:51]
    v_pk_mul_f32 v[60:61], v[60:61], s[50:51]
    v_pk_mul_f32 v[62:63], v[62:63], s[50:51]
    v_pk_mul_f32 v[64:65], v[64:65], s[50:51]
    v_pk_mul_f32 v[66:67], v[66:67], s[50:51]
    v_pk_mul_f32 v[68:69], v[68:69], s[50:51]
    v_pk_mul_f32 v[70:71], v[70:71], s[50:51]
    v_pk_mul_f32 v[72:73], v[72:73], s[50:51]
    v_pk_mul_f32 v[74:75], v[74:75], s[50:51]
    v_pk_mul_f32 v[76:77], v[76:77], s[50:51]
    v_pk_mul_f32 v[78:79], v[78:79], s[50:51]
    v_pk_mul_f32 v[80:81], v[80:81], s[50:51]
    v_pk_mul_f32 v[82:83], v[82:83], s[50:51]
    s_waitcnt lgkmcnt(0)
    s_waitcnt vmcnt(7)
    v_cvt_f32_i32 v132, v132
    v_cvt_f32_i32 v133, v133
    v_cvt_f32_i32 v134, v134
    v_cvt_f32_i32 v135, v135
    v_pk_fma_f32 v[52:53], v[132:133], v[84:85], v[52:53] op_sel:[0,0,0] op_sel_hi:[0,1,1]
    v_pk_fma_f32 v[54:55], v[132:133], v[84:85], v[54:55] op_sel:[1,0,0] op_sel_hi:[1,1,1]
    v_pk_fma_f32 v[56:57], v[134:135], v[84:85], v[56:57] op_sel:[0,0,0] op_sel_hi:[0,1,1]
    v_pk_fma_f32 v[58:59], v[134:135], v[84:85], v[58:59] op_sel:[1,0,0] op_sel_hi:[1,1,1]
    s_waitcnt vmcnt(6)
    v_cvt_f32_i32 v136, v136
    v_cvt_f32_i32 v137, v137
    v_cvt_f32_i32 v138, v138
    v_cvt_f32_i32 v139, v139
    v_pk_fma_f32 v[60:61], v[136:137], v[84:85], v[60:61] op_sel:[0,0,0] op_sel_hi:[0,1,1]
    v_pk_fma_f32 v[62:63], v[136:137], v[84:85], v[62:63] op_sel:[1,0,0] op_sel_hi:[1,1,1]
    v_pk_fma_f32 v[64:65], v[138:139], v[84:85], v[64:65] op_sel:[0,0,0] op_sel_hi:[0,1,1]
    v_pk_fma_f32 v[66:67], v[138:139], v[84:85], v[66:67] op_sel:[1,0,0] op_sel_hi:[1,1,1]
    s_waitcnt vmcnt(5)
    v_cvt_f32_i32 v140, v140
    v_cvt_f32_i32 v141, v141
    v_cvt_f32_i32 v142, v142
    v_cvt_f32_i32 v143, v143
    v_pk_fma_f32 v[68:69], v[140:141], v[84:85], v[68:69] op_sel:[0,0,0] op_sel_hi:[0,1,1]
    v_pk_fma_f32 v[70:71], v[140:141], v[84:85], v[70:71] op_sel:[1,0,0] op_sel_hi:[1,1,1]
    v_pk_fma_f32 v[72:73], v[142:143], v[84:85], v[72:73] op_sel:[0,0,0] op_sel_hi:[0,1,1]
    v_pk_fma_f32 v[74:75], v[142:143], v[84:85], v[74:75] op_sel:[1,0,0] op_sel_hi:[1,1,1]
    s_waitcnt vmcnt(4)
    v_cvt_f32_i32 v144, v144
    v_cvt_f32_i32 v145, v145
    v_cvt_f32_i32 v146, v146
    v_cvt_f32_i32 v147, v147
    v_pk_fma_f32 v[76:77], v[144:145], v[84:85], v[76:77] op_sel:[0,0,0] op_sel_hi:[0,1,1]
    v_pk_fma_f32 v[78:79], v[144:145], v[84:85], v[78:79] op_sel:[1,0,0] op_sel_hi:[1,1,1]
    v_pk_fma_f32 v[80:81], v[146:147], v[84:85], v[80:81] op_sel:[0,0,0] op_sel_hi:[0,1,1]
    v_pk_fma_f32 v[82:83], v[146:147], v[84:85], v[82:83] op_sel:[1,0,0] op_sel_hi:[1,1,1]
    s_waitcnt vmcnt(3)
    v_cvt_f32_i32 v148, v148
    v_cvt_f32_i32 v149, v149
    v_cvt_f32_i32 v150, v150
    v_cvt_f32_i32 v151, v151
    v_pk_fma_f32 v[52:53], v[148:149], v[86:87], v[52:53] op_sel:[0,0,0] op_sel_hi:[0,1,1]
    v_pk_fma_f32 v[54:55], v[148:149], v[86:87], v[54:55] op_sel:[1,0,0] op_sel_hi:[1,1,1]
    v_pk_fma_f32 v[56:57], v[150:151], v[86:87], v[56:57] op_sel:[0,0,0] op_sel_hi:[0,1,1]
    v_pk_fma_f32 v[58:59], v[150:151], v[86:87], v[58:59] op_sel:[1,0,0] op_sel_hi:[1,1,1]
    s_waitcnt vmcnt(2)
    v_cvt_f32_i32 v152, v152
    v_cvt_f32_i32 v153, v153
    v_cvt_f32_i32 v154, v154
    v_cvt_f32_i32 v155, v155
    v_pk_fma_f32 v[60:61], v[152:153], v[86:87], v[60:61] op_sel:[0,0,0] op_sel_hi:[0,1,1]
    v_pk_fma_f32 v[62:63], v[152:153], v[86:87], v[62:63] op_sel:[1,0,0] op_sel_hi:[1,1,1]
    v_pk_fma_f32 v[64:65], v[154:155], v[86:87], v[64:65] op_sel:[0,0,0] op_sel_hi:[0,1,1]
    v_pk_fma_f32 v[66:67], v[154:155], v[86:87], v[66:67] op_sel:[1,0,0] op_sel_hi:[1,1,1]
    s_waitcnt vmcnt(1)
    v_cvt_f32_i32 v156, v156
    v_cvt_f32_i32 v157, v157
    v_cvt_f32_i32 v158, v158
    v_cvt_f32_i32 v159, v159
    v_pk_fma_f32 v[68:69], v[156:157], v[86:87], v[68:69] op_sel:[0,0,0] op_sel_hi:[0,1,1]
    v_pk_fma_f32 v[70:71], v[156:157], v[86:87], v[70:71] op_sel:[1,0,0] op_sel_hi:[1,1,1]
    v_pk_fma_f32 v[72:73], v[158:159], v[86:87], v[72:73] op_sel:[0,0,0] op_sel_hi:[0,1,1]
    v_pk_fma_f32 v[74:75], v[158:159], v[86:87], v[74:75] op_sel:[1,0,0] op_sel_hi:[1,1,1]
    s_waitcnt vmcnt(0)
    v_cvt_f32_i32 v160, v160
    v_cvt_f32_i32 v161, v161
    v_cvt_f32_i32 v162, v162
    v_cvt_f32_i32 v163, v163
    v_pk_fma_f32 v[76:77], v[160:161], v[86:87], v[76:77] op_sel:[0,0,0] op_sel_hi:[0,1,1]
    v_pk_fma_f32 v[78:79], v[160:161], v[86:87], v[78:79] op_sel:[1,0,0] op_sel_hi:[1,1,1]
    v_pk_fma_f32 v[80:81], v[162:163], v[86:87], v[80:81] op_sel:[0,0,0] op_sel_hi:[0,1,1]
    v_pk_fma_f32 v[82:83], v[162:163], v[86:87], v[82:83] op_sel:[1,0,0] op_sel_hi:[1,1,1]
    s_nop 4
L_sw:
    s_cmp_lg_u32 s63, 0
    s_cbranch_scc1 L_epi
    s_mov_b32 s63, 1
    s_waitcnt vmcnt(0)
    s_cmp_lt_u32 s43, s85
    s_cbranch_scc1 L_npw
    s_mov_b64 exec, 1
    v_lshl_add_u32 v19, v19, 2, s67
    ds_write_b32 v5, v19 offset:6208
    s_mov_b64 exec, -1
    s_waitcnt lgkmcnt(0)
    s_nop 4
L_npw:
    s_barrier
    ds_read_b32 v164, v5 offset:6208
    s_waitcnt lgkmcnt(0)
    v_readfirstlane_b32 s58, v164
    s_nop 3
    s_and_b32 s68, s58, 3
    s_lshr_b32 s58, s58, 2
    s_bfe_u32 s91, s58, 0x10003
    s_add_u32 s91, s91, 2
    s_lshr_b32 s59, s58, 4
    s_lshl_b32 s59, s59, 3
    s_and_b32 s92, s58, 7
    s_add_u32 s59, s59, s92
    s_cmp_ge_u32 s68, 2
    s_cselect_b32 s58, s59, s58
    s_cselect_b32 s68, s91, s68
    s_add_u32 s58, s58, 16
    s_and_b32 s66, s68, 1
    s_lshl_b32 s42, s58, 2
    s_sub_i32 s58, s58, 56
    s_max_i32 s58, s58, 0
    s_min_u32 s58, s58, 62
    s_add_u32 s59, s58, 1
    s_nop 3
    v_readlane_b32 s91, v166, s58
    v_readlane_b32 s92, v166, s59
    s_nop 3
    s_sub_u32 s29, s92, s91
    s_cmp_lt_u32 s42, 224
    s_cselect_b32 s91, s42, s91
    s_cselect_b32 s29, 4, s29
    s_cmp_eq_u32 s29, 0
    s_cbranch_scc1 L_epi
    s_bfe_u32 s58, s91, 0x30002
    s_xor_b32 s92, s66, s31
    s_xor_b32 s92, s92, s58
    s_and_b32 s92, s92, 1
    s_lshl_b32 s92, s92, 4
    s_add_u32 s92, s92, s34
    s_lshl_b32 s59, s66, 8
    s_add_u32 s59, s59, s72
    s_cmp_ge_u32 s68, 2
    s_cselect_b32 s92, s59, s92
    s_cselect_b32 s68, 14, 15
    s_lshl_b32 s69, 1, s68
    s_lshl_b32 s95, s58, 12
    s_add_u32 s95, s95, s92
    s_lshr_b32 s59, s91, 5
    s_lshl_b32 s59, s59, 9
    s_add_u32 s95, s95, s59
    s_lshr_b32 s92, s69, 8
    s_and_b32 s59, s91, 3
    s_mul_i32 s59, s59, s92
    s_add_u32 s95, s95, s59
    s_lshl_b32 s58, s29, 1
    s_sub_u32 s58, s58, 1
    v_and_b32 v167, s58, v1
    v_mad_u32_u24 v167, v167, s92, v165
    s_lshl_b32 s59, s69, 1
    s_lshl_b32 s42, s95, 1
    s_cmp_eq_u32 s29, 1
    s_cselect_b32 s24, s12, s8
    s_cselect_b32 s25, s13, s9
    s_cselect_b32 s30, 0, s59
    buffer_load_ushort v168, v167, s[16:19], s42 offen
    buffer_load_ushort v169, v167, s[20:23], s42 offen
    s_lshl_b32 s40, s95, 9
    s_lshl_b32 s41, s95, 9
    s_add_u32 s28, s40, s30
    s_cmp_eq_u32 s29, 4
    s_cbranch_scc1 L_ntw
    s_cmp_lt_u32 s43, s85
    s_cbranch_scc1 L_ntw
    v_mov_b32 v19, 1
    s_mov_b64 exec, 1
    s_add_u32 s67, s62, s73
    s_mul_i32 s58, s62, 4096
    s_add_u32 s58, s58, s94
    buffer_atomic_add v19, v5, s[36:39], s58 offen sc0
    s_mov_b64 exec, -1
    s_nop 4
L_ntw:
    buffer_load_dwordx4 v[100:103], v0, s[8:11], s40 offen offset:0 nt
    buffer_load_dwordx4 v[104:107], v0, s[8:11], s40 offen offset:128 nt
    buffer_load_dwordx4 v[108:111], v0, s[8:11], s40 offen offset:256 nt
    buffer_load_dwordx4 v[112:115], v0, s[8:11], s40 offen offset:384 nt
    s_add_u32 s40, s40, s69
    buffer_load_dwordx4 v[116:119], v0, s[8:11], s40 offen offset:0 nt
    buffer_load_dwordx4 v[120:123], v0, s[8:11], s40 offen offset:128 nt
    buffer_load_dwordx4 v[124:127], v0, s[8:11], s40 offen offset:256 nt
    buffer_load_dwordx4 v[128:131], v0, s[8:11], s40 offen offset:384 nt
    s_add_u32 s40, s40, s69
    buffer_load_dwordx4 v[132:135], v0, s[24:27], s28 offen offset:0 nt
    buffer_load_dwordx4 v[136:139], v0, s[24:27], s28 offen offset:128 nt
    buffer_load_dwordx4 v[140:143], v0, s[24:27], s28 offen offset:256 nt
    buffer_load_dwordx4 v[144:147], v0, s[24:27], s28 offen offset:384 nt
    s_add_u32 s28, s28, s69
    s_add_u32 s40, s40, s69
    buffer_load_dwordx4 v[148:151], v0, s[24:27], s28 offen offset:0 nt
    buffer_load_dwordx4 v[152:155], v0, s[24:27], s28 offen offset:128 nt
    buffer_load_dwordx4 v[156:159], v0, s[24:27], s28 offen offset:256 nt
    buffer_load_dwordx4 v[160:163], v0, s[24:27], s28 offen offset:384 nt
    s_add_u32 s28, s28, s69
    s_add_u32 s40, s40, s69
    s_cmp_eq_u32 s29, 1
    s_cbranch_scc1 L_body2
    s_cmp_eq_u32 s29, 2
    s_cbranch_scc1 L_body4
    s_cmp_eq_u32 s29, 4
    s_cbranch_scc1 L_body8
    s_branch L_body2
    s_nop 4
L_epi:
    v_permlane32_swap_b32 v8, v9
    v_permlane32_swap_b32 v10, v11
    v_add_f32 v8, v8, v9
    v_add_f32 v10, v10, v11
    s_nop 1
    v_permlane16_swap_b32 v8, v10
    v_add_f32 v8, v8, v10
    s_nop 1
    v_add_f32_dpp v8, v8, v8 row_ror:8 row_mask:0xf bank_mask:0xf
    s_nop 1
    v_add_f32_dpp v8, v8, v8 row_ror:4 row_mask:0xf bank_mask:0xf
    s_nop 1
    v_add_f32_dpp v8, v8, v8 row_ror:2 row_mask:0xf bank_mask:0xf
    s_nop 1
    v_add_f32_dpp v8, v8, v8 row_ror:1 row_mask:0xf bank_mask:0xf
    s_nop 0
    v_readlane_b32 s80, v8, 0
    v_readlane_b32 s81, v8, 16
    v_readlane_b32 s82, v8, 32
    v_readlane_b32 s83, v8, 48
    v_permlane32_swap_b32 v52, v53
    v_permlane32_swap_b32 v54, v55
    v_permlane32_swap_b32 v56, v57
    v_permlane32_swap_b32 v58, v59
    v_permlane32_swap_b32 v60, v61
    v_permlane32_swap_b32 v62, v63
    v_permlane32_swap_b32 v64, v65
    v_permlane32_swap_b32 v66, v67
    v_permlane32_swap_b32 v68, v69
    v_permlane32_swap_b32 v70, v71
    v_permlane32_swap_b32 v72, v73
    v_permlane32_swap_b32 v74, v75
    v_permlane32_swap_b32 v76, v77
    v_permlane32_swap_b32 v78, v79
    v_permlane32_swap_b32 v80, v81
    v_permlane32_swap_b32 v82, v83
    v_add_f32 v52, v52, v53
    v_add_f32 v54, v54, v55
    v_add_f32 v56, v56, v57
    v_add_f32 v58, v58, v59
    v_add_f32 v60, v60, v61
    v_add_f32 v62, v62, v63
    v_add_f32 v64, v64, v65
    v_add_f32 v66, v66, v67
    v_add_f32 v68, v68, v69
    v_add_f32 v70, v70, v71
    v_add_f32 v72, v72, v73
    v_add_f32 v74, v74, v75
    v_add_f32 v76, v76, v77
    v_add_f32 v78, v78, v79
    v_add_f32 v80, v80, v81
    v_add_f32 v82, v82, v83
    v_permlane16_swap_b32 v52, v68
    v_permlane16_swap_b32 v54, v70
    v_permlane16_swap_b32 v56, v72
    v_permlane16_swap_b32 v58, v74
    v_permlane16_swap_b32 v60, v76
    v_permlane16_swap_b32 v62, v78
    v_permlane16_swap_b32 v64, v80
    v_permlane16_swap_b32 v66, v82
    v_add_f32 v52, v52, v68
    v_add_f32 v54, v54, v70
    v_add_f32 v56, v56, v72
    v_add_f32 v58, v58, v74
    v_add_f32 v60, v60, v76
    v_add_f32 v62, v62, v78
    v_add_f32 v64, v64, v80
    v_add_f32 v66, v66, v82
    v_add_f32_dpp v84, v52, v52 row_ror:8 row_mask:0xf bank_mask:0x3
    v_add_f32_dpp v85, v54, v54 row_ror:8 row_mask:0xf bank_mask:0x3
    v_add_f32_dpp v86, v56, v56 row_ror:8 row_mask:0xf bank_mask:0x3
    v_add_f32_dpp v87, v58, v58 row_ror:8 row_mask:0xf bank_mask:0x3
    v_add_f32_dpp v84, v60, v60 row_ror:8 row_mask:0xf bank_mask:0xc
    v_add_f32_dpp v85, v62, v62 row_ror:8 row_mask:0xf bank_mask:0xc
    v_add_f32_dpp v86, v64, v64 row_ror:8 row_mask:0xf bank_mask:0xc
    v_add_f32_dpp v87, v66, v66 row_ror:8 row_mask:0xf bank_mask:0xc
    s_mov_b32 s86, 0
    s_mov_b32 s87, -1
    v_mov_b32 v6, s81
    v_mov_b32 v7, s83
    v_cndmask_b32 v6, v6, v7, s[86:87]
    v_sub_f32 v84, v84, v6
    v_sub_f32 v85, v85, v6
    v_sub_f32 v86, v86, v6
    v_sub_f32 v87, v87, v6
    v_mov_b32 v6, s52
    v_mov_b32 v7, s53
    v_cndmask_b32 v6, v6, v7, s[86:87]
    v_sub_f32 v14, v4, v6
    v_mov_b32 v6, s80
    v_mov_b32 v7, s82
    v_cndmask_b32 v15, v6, v7, s[86:87]
    s_lshl_b32 s58, s54, 10
    v_lshlrev_b32 v5, 4, v18
    v_add_u32 v6, s58, v5
    ds_write_b128 v6, v[84:87] offset:2048
    s_lshl_b32 s58, s54, 4
    v_lshrrev_b32 v19, 5, v18
    v_lshlrev_b32 v19, 3, v19
    v_add_u32 v7, s58, v19
    ds_write_b64 v7, v[14:15] offset:6144
    s_waitcnt lgkmcnt(0)
    v_mov_b32 v6, 0
    v_mov_b32 v7, 1
    s_mov_b64 exec, 1
    ds_add_rtn_u32 v7, v6, v7 offset:6212
    s_mov_b64 exec, -1
    s_waitcnt lgkmcnt(0)
    v_readfirstlane_b32 s58, v7
    s_nop 3
    s_cmp_lg_u32 s58, 3
    s_cbranch_scc1 L_done1
    ds_read_b64 v[20:21], v19 offset:6144
    ds_read_b64 v[22:23], v19 offset:6160
    ds_read_b64 v[24:25], v19 offset:6176
    ds_read_b64 v[26:27], v19 offset:6192
    ds_read_b128 v[52:55], v5 offset:2048
    ds_read_b128 v[56:59], v5 offset:3072
    ds_read_b128 v[60:63], v5 offset:4096
    ds_read_b128 v[64:67], v5 offset:5120
    s_waitcnt lgkmcnt(0)
    v_mov_b32 v6, v20
    v_max_f32 v6, v6, v22
    v_max_f32 v6, v6, v24
    v_max_f32 v6, v6, v26
    v_sub_f32 v20, v20, v6
    v_sub_f32 v22, v22, v6
    v_sub_f32 v24, v24, v6
    v_sub_f32 v26, v26, v6
    v_exp_f32 v20, v20
    v_exp_f32 v22, v22
    v_exp_f32 v24, v24
    v_exp_f32 v26, v26
    v_mul_f32 v7, v20, v21
    v_fmac_f32 v7, v22, v23
    v_fmac_f32 v7, v24, v25
    v_fmac_f32 v7, v26, v27
    v_mul_f32 v52, v52, v20
    v_mul_f32 v53, v53, v20
    v_mul_f32 v54, v54, v20
    v_mul_f32 v55, v55, v20
    v_fmac_f32 v52, v56, v22
    v_fmac_f32 v53, v57, v22
    v_fmac_f32 v54, v58, v22
    v_fmac_f32 v55, v59, v22
    v_fmac_f32 v52, v60, v24
    v_fmac_f32 v53, v61, v24
    v_fmac_f32 v54, v62, v24
    v_fmac_f32 v55, v63, v24
    v_fmac_f32 v52, v64, v26
    v_fmac_f32 v53, v65, v26
    v_fmac_f32 v54, v66, v26
    v_fmac_f32 v55, v67, v26
    s_lshl_b32 s58, s56, 5
    s_add_u32 s58, s58, s84
    v_lshrrev_b32 v19, 5, v18
    v_lshlrev_b32 v19, 4, v19
    v_add_u32 v19, s58, v19
    v_and_b32 v5, 31, v18
    v_lshlrev_b32 v5, 4, v5
    v_lshl_add_u32 v5, v19, 9, v5
    buffer_store_dwordx4 v[52:55], v5, s[36:39], 0 offen sc1
    v_lshlrev_b32 v19, 3, v19
    s_mov_b32 s59, 262144
    buffer_store_dwordx2 v[6:7], v19, s[36:39], s59 offen sc1
    s_lshl_b32 s58, s84, 9
    v_subrev_u32 v15, s58, v5
    s_lshl_b32 s58, s84, 3
    v_subrev_u32 v16, s58, v19
    s_mul_i32 s58, s56, 4096
    s_add_u32 s58, s58, 12845056
    v_mov_b32 v14, 1
    v_mov_b32 v4, 0
    s_waitcnt vmcnt(0)
    s_mov_b64 exec, 1
    buffer_atomic_add v14, v4, s[36:39], s58 offen sc0
    s_mov_b64 exec, -1
    s_waitcnt vmcnt(0)
    v_readfirstlane_b32 s58, v14
    s_nop 3
    s_cmp_lg_u32 s58, 15
    s_cbranch_scc1 L_done1
    buffer_load_dwordx2 v[20:21], v16, s[36:39], s59 offen offset:0 sc1
    buffer_load_dwordx2 v[22:23], v16, s[36:39], s59 offen offset:8 sc1
    buffer_load_dwordx2 v[24:25], v16, s[36:39], s59 offen offset:16 sc1
    buffer_load_dwordx2 v[26:27], v16, s[36:39], s59 offen offset:24 sc1
    buffer_load_dwordx2 v[28:29], v16, s[36:39], s59 offen offset:32 sc1
    buffer_load_dwordx2 v[30:31], v16, s[36:39], s59 offen offset:40 sc1
    buffer_load_dwordx2 v[32:33], v16, s[36:39], s59 offen offset:48 sc1
    buffer_load_dwordx2 v[34:35], v16, s[36:39], s59 offen offset:56 sc1
    buffer_load_dwordx2 v[36:37], v16, s[36:39], s59 offen offset:64 sc1
    buffer_load_dwordx2 v[38:39], v16, s[36:39], s59 offen offset:72 sc1
    buffer_load_dwordx2 v[40:41], v16, s[36:39], s59 offen offset:80 sc1
    buffer_load_dwordx2 v[42:43], v16, s[36:39], s59 offen offset:88 sc1
    buffer_load_dwordx2 v[44:45], v16, s[36:39], s59 offen offset:96 sc1
    buffer_load_dwordx2 v[46:47], v16, s[36:39], s59 offen offset:104 sc1
    buffer_load_dwordx2 v[48:49], v16, s[36:39], s59 offen offset:112 sc1
    buffer_load_dwordx2 v[50:51], v16, s[36:39], s59 offen offset:120 sc1
    s_mov_b32 s58, 4096
    buffer_load_dwordx4 v[100:103], v15, s[36:39], 0 offen offset:0 sc1
    buffer_load_dwordx4 v[104:107], v15, s[36:39], 0 offen offset:512 sc1
    buffer_load_dwordx4 v[108:111], v15, s[36:39], 0 offen offset:1024 sc1
    buffer_load_dwordx4 v[112:115], v15, s[36:39], 0 offen offset:1536 sc1
    buffer_load_dwordx4 v[116:119], v15, s[36:39], 0 offen offset:2048 sc1
    buffer_load_dwordx4 v[120:123], v15, s[36:39], 0 offen offset:2560 sc1
    buffer_load_dwordx4 v[124:127], v15, s[36:39], 0 offen offset:3072 sc1
    buffer_load_dwordx4 v[128:131], v15, s[36:39], 0 offen offset:3584 sc1
    buffer_load_dwordx4 v[132:135], v15, s[36:39], s58 offen offset:0 sc1
    buffer_load_dwordx4 v[136:139], v15, s[36:39], s58 offen offset:512 sc1
    buffer_load_dwordx4 v[140:143], v15, s[36:39], s58 offen offset:1024 sc1
    buffer_load_dwordx4 v[144:147], v15, s[36:39], s58 offen offset:1536 sc1
    buffer_load_dwordx4 v[148:151], v15, s[36:39], s58 offen offset:2048 sc1
    buffer_load_dwordx4 v[152:155], v15, s[36:39], s58 offen offset:2560 sc1
    buffer_load_dwordx4 v[156:159], v15, s[36:39], s58 offen offset:3072 sc1
    buffer_load_dwordx4 v[160:163], v15, s[36:39], s58 offen offset:3584 sc1
    s_mov_b32 s8, s74
    s_mov_b32 s9, s75
    s_mov_b32 s10, 8192
    s_mov_b32 s11, 0x00020000
    s_lshl_b32 s58, s56, 9
    v_lshlrev_b32 v5, 3, v18
    s_waitcnt vmcnt(16)
    v_mov_b32 v6, v20
    v_max_f32 v6, v6, v22
    v_max_f32 v6, v6, v24
    v_max_f32 v6, v6, v26
    v_max_f32 v6, v6, v28
    v_max_f32 v6, v6, v30
    v_max_f32 v6, v6, v32
    v_max_f32 v6, v6, v34
    v_max_f32 v6, v6, v36
    v_max_f32 v6, v6, v38
    v_max_f32 v6, v6, v40
    v_max_f32 v6, v6, v42
    v_max_f32 v6, v6, v44
    v_max_f32 v6, v6, v46
    v_max_f32 v6, v6, v48
    v_max_f32 v6, v6, v50
    v_sub_f32 v20, v20, v6
    v_sub_f32 v22, v22, v6
    v_sub_f32 v24, v24, v6
    v_sub_f32 v26, v26, v6
    v_sub_f32 v28, v28, v6
    v_sub_f32 v30, v30, v6
    v_sub_f32 v32, v32, v6
    v_sub_f32 v34, v34, v6
    v_sub_f32 v36, v36, v6
    v_sub_f32 v38, v38, v6
    v_sub_f32 v40, v40, v6
    v_sub_f32 v42, v42, v6
    v_sub_f32 v44, v44, v6
    v_sub_f32 v46, v46, v6
    v_sub_f32 v48, v48, v6
    v_sub_f32 v50, v50, v6
    v_exp_f32 v20, v20
    v_exp_f32 v22, v22
    v_exp_f32 v24, v24
    v_exp_f32 v26, v26
    v_exp_f32 v28, v28
    v_exp_f32 v30, v30
    v_exp_f32 v32, v32
    v_exp_f32 v34, v34
    v_exp_f32 v36, v36
    v_exp_f32 v38, v38
    v_exp_f32 v40, v40
    v_exp_f32 v42, v42
    v_exp_f32 v44, v44
    v_exp_f32 v46, v46
    v_exp_f32 v48, v48
    v_exp_f32 v50, v50
    v_mul_f32 v7, v20, v21
    v_fmac_f32 v7, v22, v23
    v_fmac_f32 v7, v24, v25
    v_fmac_f32 v7, v26, v27
    v_fmac_f32 v7, v28, v29
    v_fmac_f32 v7, v30, v31
    v_fmac_f32 v7, v32, v33
    v_fmac_f32 v7, v34, v35
    v_fmac_f32 v7, v36, v37
    v_fmac_f32 v7, v38, v39
    v_fmac_f32 v7, v40, v41
    v_fmac_f32 v7, v42, v43
    v_fmac_f32 v7, v44, v45
    v_fmac_f32 v7, v46, v47
    v_fmac_f32 v7, v48, v49
    v_fmac_f32 v7, v50, v51
    v_rcp_f32 v7, v7
    s_waitcnt vmcnt(0)
    v_mul_f32 v100, v100, v20
    v_mul_f32 v101, v101, v20
    v_mul_f32 v102, v102, v20
    v_mul_f32 v103, v103, v20
    v_fmac_f32 v100, v104, v22
    v_fmac_f32 v101, v105, v22
    v_fmac_f32 v102, v106, v22
    v_fmac_f32 v103, v107, v22
    v_fmac_f32 v100, v108, v24
    v_fmac_f32 v101, v109, v24
    v_fmac_f32 v102, v110, v24
    v_fmac_f32 v103, v111, v24
    v_fmac_f32 v100, v112, v26
    v_fmac_f32 v101, v113, v26
    v_fmac_f32 v102, v114, v26
    v_fmac_f32 v103, v115, v26
    v_fmac_f32 v100, v116, v28
    v_fmac_f32 v101, v117, v28
    v_fmac_f32 v102, v118, v28
    v_fmac_f32 v103, v119, v28
    v_fmac_f32 v100, v120, v30
    v_fmac_f32 v101, v121, v30
    v_fmac_f32 v102, v122, v30
    v_fmac_f32 v103, v123, v30
    v_fmac_f32 v100, v124, v32
    v_fmac_f32 v101, v125, v32
    v_fmac_f32 v102, v126, v32
    v_fmac_f32 v103, v127, v32
    v_fmac_f32 v100, v128, v34
    v_fmac_f32 v101, v129, v34
    v_fmac_f32 v102, v130, v34
    v_fmac_f32 v103, v131, v34
    v_fmac_f32 v100, v132, v36
    v_fmac_f32 v101, v133, v36
    v_fmac_f32 v102, v134, v36
    v_fmac_f32 v103, v135, v36
    v_fmac_f32 v100, v136, v38
    v_fmac_f32 v101, v137, v38
    v_fmac_f32 v102, v138, v38
    v_fmac_f32 v103, v139, v38
    v_fmac_f32 v100, v140, v40
    v_fmac_f32 v101, v141, v40
    v_fmac_f32 v102, v142, v40
    v_fmac_f32 v103, v143, v40
    v_fmac_f32 v100, v144, v42
    v_fmac_f32 v101, v145, v42
    v_fmac_f32 v102, v146, v42
    v_fmac_f32 v103, v147, v42
    v_fmac_f32 v100, v148, v44
    v_fmac_f32 v101, v149, v44
    v_fmac_f32 v102, v150, v44
    v_fmac_f32 v103, v151, v44
    v_fmac_f32 v100, v152, v46
    v_fmac_f32 v101, v153, v46
    v_fmac_f32 v102, v154, v46
    v_fmac_f32 v103, v155, v46
    v_fmac_f32 v100, v156, v48
    v_fmac_f32 v101, v157, v48
    v_fmac_f32 v102, v158, v48
    v_fmac_f32 v103, v159, v48
    v_fmac_f32 v100, v160, v50
    v_fmac_f32 v101, v161, v50
    v_fmac_f32 v102, v162, v50
    v_fmac_f32 v103, v163, v50
    v_mul_f32 v100, v100, v7
    v_mul_f32 v101, v101, v7
    v_mul_f32 v102, v102, v7
    v_mul_f32 v103, v103, v7
    v_cvt_pk_bf16_f32 v100, v100, v101
    v_cvt_pk_bf16_f32 v101, v102, v103
    buffer_store_dwordx2 v[100:101], v5, s[8:11], s58 offen
L_done1:
    s_endpgm
    s_nop 4
L_init:
    s_cmp_lg_u32 s2, 256
    s_cbranch_scc1 L_done1
    s_load_dwordx4 s[60:63], s[0:1], 8
    s_load_dwordx4 s[76:79], s[0:1], 64
    v_lshrrev_b32 v6, 6, v0
    v_mul_u32_u24 v2, 4096, v0
    v_readfirstlane_b32 s54, v6
    v_lshlrev_b32 v6, 2, v6
    v_mov_b32 v3, 0
    v_mov_b32 v5, 1
    s_mov_b32 s38, 16777216
    s_mov_b32 s39, 0x00020000
    s_mov_b32 s6, 256
    s_mov_b32 s7, 0x00020000
    s_mov_b32 s10, 536870912
    s_mov_b32 s11, 0x00020000
    s_and_b32 s21, s54, 1
    s_lshl_b32 s21, s21, 24
    s_add_u32 s80, s21, 1835008
    s_add_u32 s81, s21, 41680896
    s_add_u32 s82, s21, 115081216
    s_add_u32 s83, s21, 138149888
    s_add_u32 s84, s21, 211550208
    s_add_u32 s85, s21, 284950528
    s_add_u32 s86, s21, 308019200
    s_add_u32 s87, s21, 381419520
    s_add_u32 s88, s21, 404488192
    s_add_u32 s89, s21, 477888512
    s_mov_b32 s20, 0
    s_mov_b32 s22, 1
    s_waitcnt lgkmcnt(0)
    s_mov_b32 s36, s78
    s_mov_b32 s37, s79
    s_mov_b32 s4, s76
    s_mov_b32 s5, s77
    s_cmp_lt_u32 s54, 2
    s_cselect_b32 s8, s60, s62
    s_cselect_b32 s9, s61, s63
    s_buffer_load_dword s40, s[8:11], s80 offset:81920
    s_buffer_load_dword s41, s[8:11], s81 offset:106496
    s_buffer_load_dword s42, s[8:11], s82 offset:114688
    s_buffer_load_dword s43, s[8:11], s83 offset:139264
    s_buffer_load_dword s44, s[8:11], s84 offset:147456
    s_buffer_load_dword s45, s[8:11], s85 offset:172032
    s_buffer_load_dword s46, s[8:11], s86 offset:180224
    s_buffer_load_dword s47, s[8:11], s87 offset:204800
    s_buffer_load_dword s40, s[8:11], s88 offset:212992
    s_buffer_load_dword s41, s[8:11], s89 offset:237568
    s_cmp_lg_u32 s54, 0
    s_cbranch_scc1 L_pr
    s_mov_b64 exec, 1
    buffer_atomic_add v5, v3, s[4:7], 0 offen offset:4 sc0
    s_mov_b64 exec, -1
    s_nop 4
L_pr:
    s_waitcnt lgkmcnt(0)
    s_memtime s[26:27]
    s_waitcnt lgkmcnt(0)
    s_buffer_load_dword s40, s[8:11], s80 offset:0
    s_waitcnt lgkmcnt(0)
    s_memtime s[28:29]
    s_waitcnt lgkmcnt(0)
    s_sub_u32 s30, s28, s26
    s_min_u32 s30, s30, 3000
    s_max_u32 s30, s30, 800
    s_add_i32 s20, s20, s30
    s_waitcnt lgkmcnt(0)
    s_memtime s[26:27]
    s_waitcnt lgkmcnt(0)
    s_buffer_load_dword s40, s[8:11], s80 offset:8192
    s_waitcnt lgkmcnt(0)
    s_memtime s[28:29]
    s_waitcnt lgkmcnt(0)
    s_sub_u32 s30, s28, s26
    s_min_u32 s30, s30, 3000
    s_max_u32 s30, s30, 800
    s_sub_i32 s20, s20, s30
    s_waitcnt lgkmcnt(0)
    s_memtime s[26:27]
    s_waitcnt lgkmcnt(0)
    s_buffer_load_dword s40, s[8:11], s81 offset:21120
    s_waitcnt lgkmcnt(0)
    s_memtime s[28:29]
    s_waitcnt lgkmcnt(0)
    s_sub_u32 s30, s28, s26
    s_min_u32 s30, s30, 3000
    s_max_u32 s30, s30, 800
    s_sub_i32 s20, s20, s30
    s_waitcnt lgkmcnt(0)
    s_memtime s[26:27]
    s_waitcnt lgkmcnt(0)
    s_buffer_load_dword s40, s[8:11], s81 offset:29312
    s_waitcnt lgkmcnt(0)
    s_memtime s[28:29]
    s_waitcnt lgkmcnt(0)
    s_sub_u32 s30, s28, s26
    s_min_u32 s30, s30, 3000
    s_max_u32 s30, s30, 800
    s_add_i32 s20, s20, s30
    s_cmp_lg_u32 s54, 0
    s_cbranch_scc1 L_pr2
    s_waitcnt vmcnt(0)
    v_readfirstlane_b32 s22, v5
    s_nop 3
    s_cmp_lg_u32 s22, 0
    s_cbranch_scc1 L_pr2
    s_mov_b32 s59, 12582912
    buffer_store_dword v3, v2, s[36:39], s59 offen sc1
    s_mov_b32 s59, 12845056
    buffer_store_dword v3, v2, s[36:39], s59 offen sc1
    s_nop 4
L_pr2:
    s_waitcnt lgkmcnt(0)
    s_memtime s[26:27]
    s_waitcnt lgkmcnt(0)
    s_buffer_load_dword s40, s[8:11], s82 offset:42240
    s_waitcnt lgkmcnt(0)
    s_memtime s[28:29]
    s_waitcnt lgkmcnt(0)
    s_sub_u32 s30, s28, s26
    s_min_u32 s30, s30, 3000
    s_max_u32 s30, s30, 800
    s_sub_i32 s20, s20, s30
    s_waitcnt lgkmcnt(0)
    s_memtime s[26:27]
    s_waitcnt lgkmcnt(0)
    s_buffer_load_dword s40, s[8:11], s82 offset:34048
    s_waitcnt lgkmcnt(0)
    s_memtime s[28:29]
    s_waitcnt lgkmcnt(0)
    s_sub_u32 s30, s28, s26
    s_min_u32 s30, s30, 3000
    s_max_u32 s30, s30, 800
    s_add_i32 s20, s20, s30
    s_waitcnt lgkmcnt(0)
    s_memtime s[26:27]
    s_waitcnt lgkmcnt(0)
    s_buffer_load_dword s40, s[8:11], s83 offset:63360
    s_waitcnt lgkmcnt(0)
    s_memtime s[28:29]
    s_waitcnt lgkmcnt(0)
    s_sub_u32 s30, s28, s26
    s_min_u32 s30, s30, 3000
    s_max_u32 s30, s30, 800
    s_add_i32 s20, s20, s30
    s_waitcnt lgkmcnt(0)
    s_memtime s[26:27]
    s_waitcnt lgkmcnt(0)
    s_buffer_load_dword s40, s[8:11], s83 offset:55168
    s_waitcnt lgkmcnt(0)
    s_memtime s[28:29]
    s_waitcnt lgkmcnt(0)
    s_sub_u32 s30, s28, s26
    s_min_u32 s30, s30, 3000
    s_max_u32 s30, s30, 800
    s_sub_i32 s20, s20, s30
    s_waitcnt lgkmcnt(0)
    s_memtime s[26:27]
    s_waitcnt lgkmcnt(0)
    s_buffer_load_dword s40, s[8:11], s84 offset:68096
    s_waitcnt lgkmcnt(0)
    s_memtime s[28:29]
    s_waitcnt lgkmcnt(0)
    s_sub_u32 s30, s28, s26
    s_min_u32 s30, s30, 3000
    s_max_u32 s30, s30, 800
    s_add_i32 s20, s20, s30
    s_waitcnt lgkmcnt(0)
    s_memtime s[26:27]
    s_waitcnt lgkmcnt(0)
    s_buffer_load_dword s40, s[8:11], s84 offset:76288
    s_waitcnt lgkmcnt(0)
    s_memtime s[28:29]
    s_waitcnt lgkmcnt(0)
    s_sub_u32 s30, s28, s26
    s_min_u32 s30, s30, 3000
    s_max_u32 s30, s30, 800
    s_sub_i32 s20, s20, s30
    s_waitcnt lgkmcnt(0)
    s_memtime s[26:27]
    s_waitcnt lgkmcnt(0)
    s_buffer_load_dword s40, s[8:11], s85 offset:97408
    s_waitcnt lgkmcnt(0)
    s_memtime s[28:29]
    s_waitcnt lgkmcnt(0)
    s_sub_u32 s30, s28, s26
    s_min_u32 s30, s30, 3000
    s_max_u32 s30, s30, 800
    s_sub_i32 s20, s20, s30
    s_waitcnt lgkmcnt(0)
    s_memtime s[26:27]
    s_waitcnt lgkmcnt(0)
    s_buffer_load_dword s40, s[8:11], s85 offset:89216
    s_waitcnt lgkmcnt(0)
    s_memtime s[28:29]
    s_waitcnt lgkmcnt(0)
    s_sub_u32 s30, s28, s26
    s_min_u32 s30, s30, 3000
    s_max_u32 s30, s30, 800
    s_add_i32 s20, s20, s30
    s_waitcnt lgkmcnt(0)
    s_memtime s[26:27]
    s_waitcnt lgkmcnt(0)
    s_buffer_load_dword s40, s[8:11], s86 offset:102144
    s_waitcnt lgkmcnt(0)
    s_memtime s[28:29]
    s_waitcnt lgkmcnt(0)
    s_sub_u32 s30, s28, s26
    s_min_u32 s30, s30, 3000
    s_max_u32 s30, s30, 800
    s_sub_i32 s20, s20, s30
    s_waitcnt lgkmcnt(0)
    s_memtime s[26:27]
    s_waitcnt lgkmcnt(0)
    s_buffer_load_dword s40, s[8:11], s86 offset:110336
    s_waitcnt lgkmcnt(0)
    s_memtime s[28:29]
    s_waitcnt lgkmcnt(0)
    s_sub_u32 s30, s28, s26
    s_min_u32 s30, s30, 3000
    s_max_u32 s30, s30, 800
    s_add_i32 s20, s20, s30
    s_waitcnt lgkmcnt(0)
    s_memtime s[26:27]
    s_waitcnt lgkmcnt(0)
    s_buffer_load_dword s40, s[8:11], s87 offset:115072
    s_waitcnt lgkmcnt(0)
    s_memtime s[28:29]
    s_waitcnt lgkmcnt(0)
    s_sub_u32 s30, s28, s26
    s_min_u32 s30, s30, 3000
    s_max_u32 s30, s30, 800
    s_add_i32 s20, s20, s30
    s_waitcnt lgkmcnt(0)
    s_memtime s[26:27]
    s_waitcnt lgkmcnt(0)
    s_buffer_load_dword s40, s[8:11], s87 offset:123264
    s_waitcnt lgkmcnt(0)
    s_memtime s[28:29]
    s_waitcnt lgkmcnt(0)
    s_sub_u32 s30, s28, s26
    s_min_u32 s30, s30, 3000
    s_max_u32 s30, s30, 800
    s_sub_i32 s20, s20, s30
    s_waitcnt lgkmcnt(0)
    s_memtime s[26:27]
    s_waitcnt lgkmcnt(0)
    s_buffer_load_dword s40, s[8:11], s88 offset:144384
    s_waitcnt lgkmcnt(0)
    s_memtime s[28:29]
    s_waitcnt lgkmcnt(0)
    s_sub_u32 s30, s28, s26
    s_min_u32 s30, s30, 3000
    s_max_u32 s30, s30, 800
    s_add_i32 s20, s20, s30
    s_waitcnt lgkmcnt(0)
    s_memtime s[26:27]
    s_waitcnt lgkmcnt(0)
    s_buffer_load_dword s40, s[8:11], s88 offset:136192
    s_waitcnt lgkmcnt(0)
    s_memtime s[28:29]
    s_waitcnt lgkmcnt(0)
    s_sub_u32 s30, s28, s26
    s_min_u32 s30, s30, 3000
    s_max_u32 s30, s30, 800
    s_sub_i32 s20, s20, s30
    s_waitcnt lgkmcnt(0)
    s_memtime s[26:27]
    s_waitcnt lgkmcnt(0)
    s_buffer_load_dword s40, s[8:11], s89 offset:157312
    s_waitcnt lgkmcnt(0)
    s_memtime s[28:29]
    s_waitcnt lgkmcnt(0)
    s_sub_u32 s30, s28, s26
    s_min_u32 s30, s30, 3000
    s_max_u32 s30, s30, 800
    s_sub_i32 s20, s20, s30
    s_waitcnt lgkmcnt(0)
    s_memtime s[26:27]
    s_waitcnt lgkmcnt(0)
    s_buffer_load_dword s40, s[8:11], s89 offset:149120
    s_waitcnt lgkmcnt(0)
    s_memtime s[28:29]
    s_waitcnt lgkmcnt(0)
    s_sub_u32 s30, s28, s26
    s_min_u32 s30, s30, 3000
    s_max_u32 s30, s30, 800
    s_add_i32 s20, s20, s30
    v_mov_b32 v7, s20
    ds_write_b32 v6, v7
    s_waitcnt lgkmcnt(0)
    s_barrier
    s_cmp_lg_u32 s22, 0
    s_cbranch_scc1 L_done1
    ds_read_b128 v[8:11], v3
    s_getreg_b32 s23, hwreg(HW_REG_XCC_ID, 2, 1)
    s_waitcnt lgkmcnt(0)
    v_add_u32 v8, v8, v9
    v_add_u32 v10, v10, v11
    v_readfirstlane_b32 s24, v8
    v_readfirstlane_b32 s25, v10
    s_nop 3
    s_min_i32 s26, s24, s25
    s_max_i32 s27, s24, s25
    s_xor_b32 s24, s23, 1
    s_cmp_lt_i32 s27, -1400
    s_cselect_b32 s23, s23, 2
    s_cmp_gt_i32 s26, 1400
    s_cselect_b32 s23, s24, s23
    s_add_u32 s23, s23, 1
    v_mov_b32 v4, s23
    s_waitcnt vmcnt(0)
    s_mov_b64 exec, 1
    buffer_store_dword v4, v3, s[4:7], 0 offen sc1
    s_endpgm
.section .rodata,"a"
.p2align 6
.amdhsa_kernel standalone__kv_cache_quant_int4_int2_kv_with_per_channel_or_per_token_scales__decode_kernel
  .amdhsa_next_free_vgpr 171
  .amdhsa_next_free_sgpr 100
  .amdhsa_accum_offset 172
  .amdhsa_group_segment_fixed_size 0
  .amdhsa_kernarg_size 80
  .amdhsa_user_sgpr_count 2
  .amdhsa_user_sgpr_kernarg_segment_ptr 1
  .amdhsa_system_sgpr_workgroup_id_x 1
.end_amdhsa_kernel
```
